```python
import torch

def _softmax(x, axis=-1):
    return torch.softmax(x, dim=axis)
def _gelu(x):
    return torch.nn.functional.gelu(x, approximate="tanh")
def _silu(x):
    return torch.nn.functional.silu(x)
def _sigmoid(x):
    return torch.sigmoid(x)
def _layernorm(x, axis=-1, eps=1e-5):
    m = x.mean(dim=axis, keepdim=True)
    v = x.var(dim=axis, keepdim=True, unbiased=False)
    return (x - m) / torch.sqrt(v + eps)
def _scatter_add(tgt, idx, src, axis=0):
    return tgt.clone().index_add_(axis, idx, src)
def _segment_sum(src, seg, n):
    out = torch.zeros((n,) + src.shape[1:], dtype=src.dtype)
    return out.index_add_(0, seg, src)
def _pad(x, pw):
    flat = tuple(v for pair in reversed(pw) for v in pair)
    return torch.nn.functional.pad(x, flat)

kernel_name = 'parallel_sum__gqa_block_cached__glu_gated_bilinear__decode'

def setup_inputs():

    _w = (lambda a: (lambda t: t.to(torch.bfloat16) if t.is_floating_point() else t)(torch.as_tensor(a)))
    def _A_setup():
        B, Sq, D = 2, 1, 576
        Hq, Hkv, Sk, Dh = 32, 16, 4096, 128
        assert Hq % Hkv == 0, (Hq, Hkv)
        return {
            "x": _w((lambda *s: torch.randn(*s, dtype=torch.bfloat16) * 0.05)(B, Sq, D)),
            "k_cache": _w((lambda *s: torch.randn(*s, dtype=torch.bfloat16) * 1.6)(B, Hkv, Sk, Dh)),
            "v_cache": _w((lambda *s: torch.randn(*s, dtype=torch.bfloat16) * 0.8)(B, Hkv, Sk, Dh)),
            "wq": _w((lambda *s: torch.randn(*s, dtype=torch.bfloat16) * 1.6)(D, Hq * Dh) * (D ** -0.5)),
            "wo": _w((lambda *s: torch.randn(*s, dtype=torch.bfloat16) * 0.8)(Hq * Dh, D) * ((Hq * Dh) ** -0.5)),
        }
    _A_in = _A_setup()

    def _B_setup():
        B, S, D, F = 2, 1, 576, 4608
        return {
            "x": _w((lambda *s: torch.randn(*s, dtype=torch.bfloat16) * 0.05)(B, S, D)),
            "w_gate": _w((lambda *s: torch.randn(*s, dtype=torch.bfloat16) * 0.4)(D, F) * (D ** -0.5)),
            "w_up": _w((lambda *s: torch.randn(*s, dtype=torch.bfloat16) * 0.4)(D, F) * (D ** -0.5)),
            "w_down": _w((lambda *s: torch.randn(*s, dtype=torch.bfloat16) * 0.4)(F, D) * (F ** -0.5)),
        }
    _B_in = _B_setup()

    return {
        "A_x": _A_in["x"],
        "A_k_cache": _A_in["k_cache"],
        "A_v_cache": _A_in["v_cache"],
        "A_wq": _A_in["wq"],
        "A_wo": _A_in["wo"],
        "B_x": _B_in["x"],
        "B_w_gate": _B_in["w_gate"],
        "B_w_up": _B_in["w_up"],
        "B_w_down": _B_in["w_down"],
    }

def reference(A_x, A_k_cache, A_v_cache, A_wq, A_wo, B_x, B_w_gate, B_w_up, B_w_down):
    def _A_ref(x, k_cache, v_cache, wq, wo):
        B, Sq, D = x.shape
        Hq, Dh = 32, 128
        Hkv = k_cache.shape[1]
        rep = Hq // Hkv
        q = (lambda x, *d: x.permute(*d))((x @ wq).reshape(B, Sq, Hq, Dh), 0, 2, 1, 3)
        k = (lambda x, n, axis: torch.repeat_interleave(x, n, dim=axis))(k_cache, rep, axis=1)
        v = (lambda x, n, axis: torch.repeat_interleave(x, n, dim=axis))(v_cache, rep, axis=1)
        scores = torch.einsum("bhqd,bhkd->bhqk", q, k) * (Dh ** -0.5)
        p = _softmax(scores, axis=-1)
        o = torch.einsum("bhqk,bhkd->bhqd", p, v)
        return (lambda x, *d: x.permute(*d))(o, 0, 2, 1, 3).reshape(B, Sq, Hq * Dh) @ wo

    def _B_ref(x, w_gate, w_up, w_down):
        g = torch.einsum("bsd,df->bsf", x, w_gate)
        u = torch.einsum("bsd,df->bsf", x, w_up)
        h = g * u
        return torch.einsum("bsf,fd->bsd", h, w_down)

    x = A_x
    xn = _layernorm(x, axis=-1)
    return x + _A_ref(xn, A_k_cache, A_v_cache, A_wq, A_wo) + _B_ref(xn, B_w_gate, B_w_up, B_w_down)
```

```asm
; @launch grid=(256,1,1) block=(1024,1,1) lds=87040
.amdgcn_target "amdgcn-amd-amdhsa--gfx950"
.text
.globl parallel_sum__gqa_block_cached__glu_gated_bilinear__decode_kernel
.p2align 8
.type parallel_sum__gqa_block_cached__glu_gated_bilinear__decode_kernel,@function
parallel_sum__gqa_block_cached__glu_gated_bilinear__decode_kernel:
    s_cmp_ge_u32 s2, 256
    s_cbranch_scc1 L_end
    v_and_b32 v1, 63, v0
    v_lshrrev_b32 v4, 6, v0
    v_lshrrev_b32 v2, 4, v1
    v_and_b32 v3, 15, v1
    v_readfirstlane_b32 s101, v4
    s_nop 0
    s_mov_b32 s99, s101
    s_cmp_eq_u32 s101, 15
    s_nop 0
    s_cbranch_scc1 L_initw
    s_load_dwordx16 s[40:55], s[0:1], 0
    s_load_dwordx8 s[56:63], s[0:1], 64
    s_branch L_initd
L_initw:
    v_lshlrev_b32 v4, 2, v1
    v_mov_b32 v5, 0
    ds_write_b32 v4, v5 offset:0
    ds_write_b32 v4, v5 offset:256
    ds_write_b32 v4, v5 offset:3328
    ds_write_b32 v4, v5 offset:3968
    v_mov_b32 v6, -1
    ds_write_b32 v4, v6 offset:6016
    ds_write_b32 v4, v6 offset:6272
    v_lshlrev_b32 v6, 3, v1
    v_mov_b32 v8, 0xf149f2ca
    v_mov_b32 v9, 0
    ds_write_b64 v6, v[8:9] offset:3456
    s_waitcnt lgkmcnt(0)
    s_load_dwordx16 s[40:55], s[0:1], 0
    s_load_dwordx8 s[56:63], s[0:1], 64
L_initd:
    s_barrier
    v_mov_b32 v125, 0
    v_mov_b32 v108, 0
    v_mov_b32 v109, 0
    v_mov_b32 v110, 0
    v_mov_b32 v111, 0
    v_mov_b32 v112, 0
    v_mov_b32 v113, 0
    v_mov_b32 v114, 0
    v_mov_b32 v115, 0
    v_mov_b32 v116, 0
    v_mov_b32 v117, 0
    s_add_u32 s36, s101, 15
    s_and_b32 s36, s36, 15
    s_lshr_b32 s37, s2, 4
    s_and_b32 s38, s2, 15
    s_lshr_b32 s39, s38, 3
    s_mov_b32 s64, 0x110011
    s_mov_b32 s65, 0x110011
    s_mov_b32 s66, 0x220022
    s_mov_b32 s67, 0x220022
    s_mov_b32 s68, 0x440044
    s_mov_b32 s69, 0x440044
    s_mov_b32 s70, 0x880088
    s_mov_b32 s71, 0x880088
    s_mov_b32 s72, 0x11001100
    s_mov_b32 s73, 0x11001100
    s_mov_b32 s74, 0x22002200
    s_mov_b32 s75, 0x22002200
    s_mov_b32 s76, 0x44004400
    s_mov_b32 s77, 0x44004400
    s_mov_b32 s78, 0x88008800
    s_mov_b32 s79, 0x88008800
    s_mov_b32 s80, 0x05040100
    s_mov_b32 s81, 0x07060302
    s_mov_b32 s100, 0xfff
    s_mov_b32 s30, 0x900
    s_mov_b32 s31, 0x20000
    s_mov_b32 s6, 0x2000000
    s_mov_b32 s7, 0x20000
    s_mov_b32 s10, 0x2000000
    s_mov_b32 s11, 0x20000
    s_mov_b32 s18, 0x800000
    s_mov_b32 s19, 0x20000
    s_mov_b32 s22, 0x480000
    s_mov_b32 s23, 0x20000
    s_mov_b32 s26, 0x510000
    s_mov_b32 s27, 0x20000
    s_mov_b32 s34, 0x900
    s_mov_b32 s35, 0x20000
    s_mov_b32 s96, 0x65d43210
    s_mov_b32 s97, 0xfc8b7ae9
    s_lshl_b32 s89, s38, 2
    s_lshr_b64 s[96:97], s[96:97], s89
    s_and_b32 s101, s96, 15
    s_mul_i32 s89, s37, 9
    s_add_u32 s85, s89, s101
    s_and_b32 s93, s85, 1
    s_lshr_b32 s90, s85, 2
    s_lshl_b32 s87, s90, 8
    s_mov_b32 s86, 9216
    s_bfe_u32 s92, s85, 0x10001
    s_mov_b32 s14, 0x510000
    s_mov_b32 s15, 0x20000
    s_mov_b32 s84, 1
    s_cmp_lt_u32 s101, 9
    s_cbranch_scc1 L_role_done
    s_sub_u32 s89, s101, 9
    s_and_b32 s93, s89, 1
    s_lshl_b32 s90, s37, 2
    s_add_u32 s85, s90, s89
    s_lshr_b32 s91, s85, 1
    s_lshl_b32 s87, s91, 8
    s_add_u32 s85, s85, 144
    s_mov_b32 s86, 8192
    s_mov_b32 s92, 2
    s_mov_b32 s14, 0x480000
    s_cmp_lt_u32 s101, 13
    s_cselect_b32 s84, 1, 0
L_role_done:
    s_mul_i32 s89, s93, 288
    s_mul_i32 s89, s89, s86
    s_add_u32 s87, s87, s89
    s_mul_i32 s94, s2, 18
    s_mov_b32 s96, 0xdcba9873
    s_mov_b32 s97, 0x654210fe
    s_mov_b32 s89, 0xdcba9873
    s_mov_b32 s90, 0x654210fe
    s_cmp_eq_u32 s84, 0
    s_cselect_b32 s96, s89, s96
    s_cselect_b32 s97, s90, s97
    s_lshl_b32 s89, s99, 2
    s_lshr_b64 s[96:97], s[96:97], s89
    s_and_b32 s3, s96, 15
    v_mul_lo_u32 v6, v2, s86
    v_lshlrev_b32 v7, 4, v3
    v_add_u32 v6, v6, v7
    s_lshl_b32 s89, s36, 5
    s_mul_i32 s89, s89, s86
    s_add_u32 s95, s89, s87
    s_lshl_b32 s98, s86, 2
    v_lshrrev_b32 v8, 5, v1
    v_mul_u32_u24 v8, 1152, v8
    v_and_b32 v9, 31, v1
    v_lshlrev_b32 v9, 2, v9
    v_add_u32 v9, v9, v8
    s_waitcnt lgkmcnt(0)
    s_mov_b32 s28, s40
    s_mov_b32 s29, s41
    s_cmp_lg_u32 s36, 15
    s_cbranch_scc1 L_nox
    buffer_load_dword v104, v9, s[28:31], 0 offen offset:0
    buffer_load_dword v105, v9, s[28:31], 0 offen offset:128
    buffer_load_dword v106, v9, s[28:31], 0 offen offset:256
    buffer_load_dword v107, v9, s[28:31], 0 offen offset:384
    buffer_load_dword v108, v9, s[28:31], 0 offen offset:512
    buffer_load_dword v109, v9, s[28:31], 0 offen offset:640
    buffer_load_dword v110, v9, s[28:31], 0 offen offset:768
    buffer_load_dword v111, v9, s[28:31], 0 offen offset:896
    buffer_load_dword v112, v9, s[28:31], 0 offen offset:1024
L_nox:
    s_cmp_eq_u32 s92, 1
    s_cselect_b32 s12, s54, s52
    s_cselect_b32 s13, s55, s53
    s_cmp_eq_u32 s92, 2
    s_cselect_b32 s12, s46, s12
    s_cselect_b32 s13, s47, s13
    s_mov_b32 s4, s42
    s_mov_b32 s5, s43
    s_mov_b32 s8, s44
    s_mov_b32 s9, s45
    s_mov_b32 s16, s62
    s_mov_b32 s17, s63
    s_mov_b32 s20, s48
    s_mov_b32 s21, s49
    s_mov_b32 s24, s56
    s_mov_b32 s25, s57
    s_mov_b32 s32, s58
    s_mov_b32 s33, s59
    s_load_dword s83, s[62:63], 0
    s_lshl_b32 s89, s39, 4
    s_add_u32 s89, s89, s37
    s_lshl_b32 s40, s89, 20
    s_lshl_b32 s43, s89, 8
    s_add_u32 s43, s43, 1966080
    s_add_u32 s89, s38, s37
    s_and_b32 s89, s89, 7
    s_mul_i32 s41, s89, 16
    s_mov_b32 s44, s3
    s_cmp_eq_u32 s36, 15
    s_cbranch_scc1 L_service
    s_cmp_eq_u32 s84, 0
    s_cbranch_scc1 L_pre
    s_cmp_ge_u32 s36, 9
    s_cbranch_scc1 L_pre
    buffer_load_dwordx4 v[72:75], v6, s[12:15], s95 offen nt
    s_add_u32 s95, s95, s98
    buffer_load_dwordx4 v[76:79], v6, s[12:15], s95 offen nt
    s_add_u32 s95, s95, s98
    buffer_load_dwordx4 v[80:83], v6, s[12:15], s95 offen nt
    s_add_u32 s95, s95, s98
    buffer_load_dwordx4 v[84:87], v6, s[12:15], s95 offen nt
    s_add_u32 s95, s95, s98
    buffer_load_dwordx4 v[88:91], v6, s[12:15], s95 offen nt
    s_add_u32 s95, s95, s98
    buffer_load_dwordx4 v[92:95], v6, s[12:15], s95 offen nt
    s_add_u32 s95, s95, s98
    buffer_load_dwordx4 v[96:99], v6, s[12:15], s95 offen nt
    s_add_u32 s95, s95, s98
    buffer_load_dwordx4 v[100:103], v6, s[12:15], s95 offen nt
    v_mov_b32 v4, 16
    v_mov_b32 v5, 1
    s_mov_b64 exec, 1
    ds_add_u32 v4, v5
    s_mov_b64 exec, -1
    v_bfe_u32 v6, v3, 2, 1
    v_mul_u32_u24 v6, 1152, v6
    v_lshlrev_b32 v7, 4, v2
    v_add_u32 v6, v6, v7
    s_mul_i32 s90, s93, 9
    s_add_u32 s90, s90, s36
    s_lshl_b32 s90, s90, 6
    v_add_u32 v6, s90, v6
    v_mov_b32 v4, 4
    s_mov_b32 s95, 0
L_xn_1:
    ds_read_b32 v5, v4
    s_waitcnt lgkmcnt(0)
    v_readfirstlane_b32 s89, v5
    s_nop 0
    s_cmp_ge_u32 s89, 1
    s_nop 1
    s_cbranch_scc1 L_xnd_2
    s_sleep 1
    s_add_u32 s95, s95, 1
    s_cmp_lt_u32 s95, 1000000
    s_cbranch_scc1 L_xn_1
L_xnd_2:
    ds_read_b128 v[12:15], v6 offset:512
    s_waitcnt vmcnt(0) lgkmcnt(0)
    v_perm_b32 v20, v76, v72, s80
    v_perm_b32 v21, v84, v80, s80
    v_perm_b32 v22, v92, v88, s80
    v_perm_b32 v23, v100, v96, s80
    v_cndmask_b32_e64 v28, 0, v12, s[64:65]
    v_cndmask_b32_e64 v29, 0, v13, s[64:65]
    v_cndmask_b32_e64 v30, 0, v14, s[64:65]
    v_cndmask_b32_e64 v31, 0, v15, s[64:65]
    s_nop 1
    v_mfma_f32_16x16x32_bf16 v[16:19], v[28:31], v[20:23], 0
    v_perm_b32 v24, v76, v72, s81
    v_perm_b32 v25, v84, v80, s81
    v_perm_b32 v26, v92, v88, s81
    v_perm_b32 v27, v100, v96, s81
    v_cndmask_b32_e64 v32, 0, v12, s[66:67]
    v_cndmask_b32_e64 v33, 0, v13, s[66:67]
    v_cndmask_b32_e64 v34, 0, v14, s[66:67]
    v_cndmask_b32_e64 v35, 0, v15, s[66:67]
    s_nop 1
    v_mfma_f32_16x16x32_bf16 v[16:19], v[32:35], v[24:27], v[16:19]
    v_perm_b32 v20, v77, v73, s80
    v_perm_b32 v21, v85, v81, s80
    v_perm_b32 v22, v93, v89, s80
    v_perm_b32 v23, v101, v97, s80
    v_cndmask_b32_e64 v28, 0, v12, s[68:69]
    v_cndmask_b32_e64 v29, 0, v13, s[68:69]
    v_cndmask_b32_e64 v30, 0, v14, s[68:69]
    v_cndmask_b32_e64 v31, 0, v15, s[68:69]
    s_nop 1
    v_mfma_f32_16x16x32_bf16 v[16:19], v[28:31], v[20:23], v[16:19]
    v_perm_b32 v24, v77, v73, s81
    v_perm_b32 v25, v85, v81, s81
    v_perm_b32 v26, v93, v89, s81
    v_perm_b32 v27, v101, v97, s81
    v_cndmask_b32_e64 v32, 0, v12, s[70:71]
    v_cndmask_b32_e64 v33, 0, v13, s[70:71]
    v_cndmask_b32_e64 v34, 0, v14, s[70:71]
    v_cndmask_b32_e64 v35, 0, v15, s[70:71]
    s_nop 1
    v_mfma_f32_16x16x32_bf16 v[16:19], v[32:35], v[24:27], v[16:19]
    v_perm_b32 v20, v78, v74, s80
    v_perm_b32 v21, v86, v82, s80
    v_perm_b32 v22, v94, v90, s80
    v_perm_b32 v23, v102, v98, s80
    v_cndmask_b32_e64 v28, 0, v12, s[72:73]
    v_cndmask_b32_e64 v29, 0, v13, s[72:73]
    v_cndmask_b32_e64 v30, 0, v14, s[72:73]
    v_cndmask_b32_e64 v31, 0, v15, s[72:73]
    s_nop 1
    v_mfma_f32_16x16x32_bf16 v[16:19], v[28:31], v[20:23], v[16:19]
    v_perm_b32 v24, v78, v74, s81
    v_perm_b32 v25, v86, v82, s81
    v_perm_b32 v26, v94, v90, s81
    v_perm_b32 v27, v102, v98, s81
    v_cndmask_b32_e64 v32, 0, v12, s[74:75]
    v_cndmask_b32_e64 v33, 0, v13, s[74:75]
    v_cndmask_b32_e64 v34, 0, v14, s[74:75]
    v_cndmask_b32_e64 v35, 0, v15, s[74:75]
    s_nop 1
    v_mfma_f32_16x16x32_bf16 v[16:19], v[32:35], v[24:27], v[16:19]
    v_perm_b32 v20, v79, v75, s80
    v_perm_b32 v21, v87, v83, s80
    v_perm_b32 v22, v95, v91, s80
    v_perm_b32 v23, v103, v99, s80
    v_cndmask_b32_e64 v28, 0, v12, s[76:77]
    v_cndmask_b32_e64 v29, 0, v13, s[76:77]
    v_cndmask_b32_e64 v30, 0, v14, s[76:77]
    v_cndmask_b32_e64 v31, 0, v15, s[76:77]
    s_nop 1
    v_mfma_f32_16x16x32_bf16 v[16:19], v[28:31], v[20:23], v[16:19]
    v_perm_b32 v24, v79, v75, s81
    v_perm_b32 v25, v87, v83, s81
    v_perm_b32 v26, v95, v91, s81
    v_perm_b32 v27, v103, v99, s81
    v_cndmask_b32_e64 v32, 0, v12, s[78:79]
    v_cndmask_b32_e64 v33, 0, v13, s[78:79]
    v_cndmask_b32_e64 v34, 0, v14, s[78:79]
    v_cndmask_b32_e64 v35, 0, v15, s[78:79]
    s_nop 1
    v_mfma_f32_16x16x32_bf16 v[16:19], v[32:35], v[24:27], v[16:19]
    s_lshl_b32 s89, s36, 10
    v_lshlrev_b32 v6, 4, v1
    v_add_u32 v6, s89, v6
    s_nop 4
    ds_write_b128 v6, v[16:19] offset:6656
    v_mov_b32 v4, 0
    v_mov_b32 v5, 1
    s_mov_b64 exec, 1
    ds_add_rtn_u32 v5, v4, v5
    s_mov_b64 exec, -1
    v_and_b32 v7, 1, v2
    v_lshlrev_b32 v7, 9, v7
    v_lshlrev_b32 v8, 5, v3
    v_add_u32 v7, v7, v8
    v_lshrrev_b32 v8, 1, v2
    v_lshlrev_b32 v8, 4, v8
    v_add_u32 v7, v7, v8
    v_lshlrev_b32 v6, 4, v1
    s_lshl_b32 s90, s85, 10
    s_add_u32 s90, s90, 4096
    s_waitcnt lgkmcnt(0)
    v_readfirstlane_b32 s89, v5
    s_nop 0
    s_cmp_lg_u32 s89, 8
    s_nop 1
    s_cbranch_scc1 L_notlast
    s_setprio 3
    ds_read_b128 v[40:43], v6 offset:6656
    ds_read_b128 v[44:47], v6 offset:7680
    ds_read_b128 v[48:51], v6 offset:8704
    ds_read_b128 v[52:55], v6 offset:9728
    ds_read_b128 v[56:59], v6 offset:10752
    ds_read_b128 v[60:63], v6 offset:11776
    ds_read_b128 v[64:67], v6 offset:12800
    ds_read_b128 v[68:71], v6 offset:13824
    ds_read_b128 v[72:75], v6 offset:14848
    s_add_u32 s82, s83, 1
    s_and_b32 s82, s82, 0xfff
    v_mov_b32 v124, s82
    s_waitcnt lgkmcnt(0)
    v_add_f32 v40, v40, v44
    v_add_f32 v48, v48, v52
    v_add_f32 v56, v56, v60
    v_add_f32 v64, v64, v68
    v_add_f32 v41, v41, v45
    v_add_f32 v49, v49, v53
    v_add_f32 v57, v57, v61
    v_add_f32 v65, v65, v69
    v_add_f32 v42, v42, v46
    v_add_f32 v50, v50, v54
    v_add_f32 v58, v58, v62
    v_add_f32 v66, v66, v70
    v_add_f32 v43, v43, v47
    v_add_f32 v51, v51, v55
    v_add_f32 v59, v59, v63
    v_add_f32 v67, v67, v71
    v_add_f32 v40, v40, v48
    v_add_f32 v56, v56, v64
    v_add_f32 v41, v41, v49
    v_add_f32 v57, v57, v65
    v_add_f32 v42, v42, v50
    v_add_f32 v58, v58, v66
    v_add_f32 v43, v43, v51
    v_add_f32 v59, v59, v67
    v_add_f32 v40, v40, v56
    v_add_f32 v41, v41, v57
    v_add_f32 v42, v42, v58
    v_add_f32 v43, v43, v59
    v_add_f32 v40, v40, v72
    v_add_f32 v41, v41, v73
    v_add_f32 v42, v42, v74
    v_add_f32 v43, v43, v75
    v_add_u32 v40, 0x800, v40
    v_add_u32 v41, 0x800, v41
    v_add_u32 v42, 0x800, v42
    v_add_u32 v43, 0x800, v43
    v_bfi_b32 v40, s100, v124, v40
    v_bfi_b32 v41, s100, v124, v41
    v_bfi_b32 v42, s100, v124, v42
    v_bfi_b32 v43, s100, v124, v43
    buffer_store_dwordx4 v[40:43], v7, s[16:19], s90 offen sc1
    s_setprio 0
L_notlast:
L_waitwi:
    v_mov_b32 v4, 16
    s_mov_b32 s95, 0
L_wi_3:
    ds_read_b32 v5, v4
    s_waitcnt lgkmcnt(0)
    v_readfirstlane_b32 s89, v5
    s_nop 0
    s_cmp_ge_u32 s89, 9
    s_nop 1
    s_cbranch_scc1 L_wid_4
    s_sleep 1
    s_add_u32 s95, s95, 1
    s_cmp_lt_u32 s95, 1000000
    s_cbranch_scc1 L_wi_3
L_wid_4:
    s_branch L_pre
L_service:
    s_lshl_b32 s89, s2, 4
    s_mul_i32 s89, s89, 1152
    s_mul_i32 s90, s94, 1152
    v_mov_b32 v4, 0
    s_mov_b64 exec, 1
    buffer_load_dword v20, v4, s[20:23], s89 offen
    buffer_load_dword v21, v4, s[24:27], s90 offen
    buffer_load_dword v22, v4, s[32:35], 0 offen
    s_mov_b64 exec, -1
    v_lshrrev_b32 v4, 5, v1
    v_mul_u32_u24 v5, 1152, v4
    v_bfe_u32 v8, v1, 4, 1
    v_lshlrev_b32 v8, 6, v8
    v_add_u32 v8, v8, v5
    v_and_b32 v9, 1, v1
    v_lshlrev_b32 v9, 5, v9
    v_add_u32 v8, v8, v9
    v_bfe_u32 v9, v1, 1, 3
    v_lshlrev_b32 v9, 1, v9
    v_add_u32 v8, v8, v9
    s_waitcnt vmcnt(3)
    v_lshlrev_b32 v72, 16, v104
    v_and_b32 v73, 0xffff0000, v104
    v_lshlrev_b32 v74, 16, v105
    v_and_b32 v75, 0xffff0000, v105
    v_lshlrev_b32 v76, 16, v106
    v_and_b32 v77, 0xffff0000, v106
    v_lshlrev_b32 v78, 16, v107
    v_and_b32 v79, 0xffff0000, v107
    v_lshlrev_b32 v80, 16, v108
    v_and_b32 v81, 0xffff0000, v108
    v_lshlrev_b32 v82, 16, v109
    v_and_b32 v83, 0xffff0000, v109
    v_lshlrev_b32 v84, 16, v110
    v_and_b32 v85, 0xffff0000, v110
    v_lshlrev_b32 v86, 16, v111
    v_and_b32 v87, 0xffff0000, v111
    v_lshlrev_b32 v88, 16, v112
    v_and_b32 v89, 0xffff0000, v112
    v_add_f32 v16, v72, v76
    v_add_f32 v17, v73, v77
    v_add_f32 v18, v74, v78
    v_add_f32 v19, v75, v79
    v_add_f32 v16, v16, v80
    v_add_f32 v17, v17, v81
    v_add_f32 v18, v18, v82
    v_add_f32 v19, v19, v83
    v_add_f32 v16, v16, v84
    v_add_f32 v17, v17, v85
    v_add_f32 v18, v18, v86
    v_add_f32 v19, v19, v87
    v_add_f32 v16, v16, v88
    v_add_f32 v17, v17, v89
    v_add_f32 v16, v16, v18
    v_add_f32 v17, v17, v19
    v_add_f32 v12, v16, v17
    s_nop 1
    v_add_f32_dpp v12, v12, v12 quad_perm:[1,0,3,2] row_mask:0xf bank_mask:0xf
    s_nop 1
    v_add_f32_dpp v12, v12, v12 quad_perm:[2,3,0,1] row_mask:0xf bank_mask:0xf
    s_nop 1
    v_add_f32_dpp v12, v12, v12 row_half_mirror row_mask:0xf bank_mask:0xf
    s_nop 1
    v_add_f32_dpp v12, v12, v12 row_mirror row_mask:0xf bank_mask:0xf
    v_mov_b32 v13, v12
    s_nop 1
    v_permlane16_swap_b32 v13, v12
    v_add_f32 v12, v12, v13
    v_mul_f32 v12, 0x3ae38e39, v12
    v_sub_f32 v40, v72, v12
    v_sub_f32 v41, v73, v12
    v_sub_f32 v42, v74, v12
    v_sub_f32 v43, v75, v12
    v_sub_f32 v44, v76, v12
    v_sub_f32 v45, v77, v12
    v_sub_f32 v46, v78, v12
    v_sub_f32 v47, v79, v12
    v_sub_f32 v48, v80, v12
    v_sub_f32 v49, v81, v12
    v_sub_f32 v50, v82, v12
    v_sub_f32 v51, v83, v12
    v_sub_f32 v52, v84, v12
    v_sub_f32 v53, v85, v12
    v_sub_f32 v54, v86, v12
    v_sub_f32 v55, v87, v12
    v_sub_f32 v56, v88, v12
    v_sub_f32 v57, v89, v12
    v_mul_f32 v16, v40, v40
    v_mul_f32 v17, v41, v41
    v_mul_f32 v18, v42, v42
    v_mul_f32 v19, v43, v43
    v_fmac_f32 v16, v44, v44
    v_fmac_f32 v17, v45, v45
    v_fmac_f32 v18, v46, v46
    v_fmac_f32 v19, v47, v47
    v_fmac_f32 v16, v48, v48
    v_fmac_f32 v17, v49, v49
    v_fmac_f32 v18, v50, v50
    v_fmac_f32 v19, v51, v51
    v_fmac_f32 v16, v52, v52
    v_fmac_f32 v17, v53, v53
    v_fmac_f32 v18, v54, v54
    v_fmac_f32 v19, v55, v55
    v_fmac_f32 v16, v56, v56
    v_fmac_f32 v17, v57, v57
    v_add_f32 v16, v16, v18
    v_add_f32 v17, v17, v19
    v_add_f32 v13, v16, v17
    s_nop 1
    v_add_f32_dpp v13, v13, v13 quad_perm:[1,0,3,2] row_mask:0xf bank_mask:0xf
    s_nop 1
    v_add_f32_dpp v13, v13, v13 quad_perm:[2,3,0,1] row_mask:0xf bank_mask:0xf
    s_nop 1
    v_add_f32_dpp v13, v13, v13 row_half_mirror row_mask:0xf bank_mask:0xf
    s_nop 1
    v_add_f32_dpp v13, v13, v13 row_mirror row_mask:0xf bank_mask:0xf
    v_mov_b32 v14, v13
    s_nop 1
    v_permlane16_swap_b32 v14, v13
    v_add_f32 v13, v13, v14
    v_mul_f32 v13, 0x3ae38e39, v13
    v_cvt_pk_bf16_f32 v13, v13, v13
    v_lshlrev_b32 v13, 16, v13
    v_add_f32 v13, 0x3727c5ac, v13
    v_cvt_pk_bf16_f32 v13, v13, v13
    v_lshlrev_b32 v13, 16, v13
    v_sqrt_f32 v13, v13
    v_cvt_pk_bf16_f32 v12, v12, v12
    v_lshlrev_b32 v12, 16, v12
    v_cvt_pk_bf16_f32 v13, v13, v13
    v_lshlrev_b32 v13, 16, v13
    v_rcp_f32 v14, v13
    v_sub_f32 v72, v72, v12
    v_sub_f32 v73, v73, v12
    v_sub_f32 v74, v74, v12
    v_sub_f32 v75, v75, v12
    v_sub_f32 v76, v76, v12
    v_sub_f32 v77, v77, v12
    v_sub_f32 v78, v78, v12
    v_sub_f32 v79, v79, v12
    v_sub_f32 v80, v80, v12
    v_sub_f32 v81, v81, v12
    v_sub_f32 v82, v82, v12
    v_sub_f32 v83, v83, v12
    v_sub_f32 v84, v84, v12
    v_sub_f32 v85, v85, v12
    v_sub_f32 v86, v86, v12
    v_sub_f32 v87, v87, v12
    v_sub_f32 v88, v88, v12
    v_sub_f32 v89, v89, v12
    v_cvt_pk_bf16_f32 v104, v72, v73
    v_cvt_pk_bf16_f32 v105, v74, v75
    v_cvt_pk_bf16_f32 v106, v76, v77
    v_cvt_pk_bf16_f32 v107, v78, v79
    v_cvt_pk_bf16_f32 v108, v80, v81
    v_cvt_pk_bf16_f32 v109, v82, v83
    v_cvt_pk_bf16_f32 v110, v84, v85
    v_cvt_pk_bf16_f32 v111, v86, v87
    v_cvt_pk_bf16_f32 v112, v88, v89
    v_lshlrev_b32 v72, 16, v104
    v_and_b32 v73, 0xffff0000, v104
    v_lshlrev_b32 v74, 16, v105
    v_and_b32 v75, 0xffff0000, v105
    v_lshlrev_b32 v76, 16, v106
    v_and_b32 v77, 0xffff0000, v106
    v_lshlrev_b32 v78, 16, v107
    v_and_b32 v79, 0xffff0000, v107
    v_lshlrev_b32 v80, 16, v108
    v_and_b32 v81, 0xffff0000, v108
    v_lshlrev_b32 v82, 16, v109
    v_and_b32 v83, 0xffff0000, v109
    v_lshlrev_b32 v84, 16, v110
    v_and_b32 v85, 0xffff0000, v110
    v_lshlrev_b32 v86, 16, v111
    v_and_b32 v87, 0xffff0000, v111
    v_lshlrev_b32 v88, 16, v112
    v_and_b32 v89, 0xffff0000, v112
    v_mul_f32 v40, v72, v14
    v_mul_f32 v41, v73, v14
    v_mul_f32 v42, v74, v14
    v_mul_f32 v43, v75, v14
    v_mul_f32 v44, v76, v14
    v_mul_f32 v45, v77, v14
    v_mul_f32 v46, v78, v14
    v_mul_f32 v47, v79, v14
    v_mul_f32 v48, v80, v14
    v_mul_f32 v49, v81, v14
    v_mul_f32 v50, v82, v14
    v_mul_f32 v51, v83, v14
    v_mul_f32 v52, v84, v14
    v_mul_f32 v53, v85, v14
    v_mul_f32 v54, v86, v14
    v_mul_f32 v55, v87, v14
    v_mul_f32 v56, v88, v14
    v_mul_f32 v57, v89, v14
    v_fma_f32 v72, -v40, v13, v72
    v_fma_f32 v73, -v41, v13, v73
    v_fma_f32 v74, -v42, v13, v74
    v_fma_f32 v75, -v43, v13, v75
    v_fma_f32 v76, -v44, v13, v76
    v_fma_f32 v77, -v45, v13, v77
    v_fma_f32 v78, -v46, v13, v78
    v_fma_f32 v79, -v47, v13, v79
    v_fma_f32 v80, -v48, v13, v80
    v_fma_f32 v81, -v49, v13, v81
    v_fma_f32 v82, -v50, v13, v82
    v_fma_f32 v83, -v51, v13, v83
    v_fma_f32 v84, -v52, v13, v84
    v_fma_f32 v85, -v53, v13, v85
    v_fma_f32 v86, -v54, v13, v86
    v_fma_f32 v87, -v55, v13, v87
    v_fma_f32 v88, -v56, v13, v88
    v_fma_f32 v89, -v57, v13, v89
    v_fma_f32 v40, v72, v14, v40
    v_fma_f32 v41, v73, v14, v41
    v_fma_f32 v42, v74, v14, v42
    v_fma_f32 v43, v75, v14, v43
    v_fma_f32 v44, v76, v14, v44
    v_fma_f32 v45, v77, v14, v45
    v_fma_f32 v46, v78, v14, v46
    v_fma_f32 v47, v79, v14, v47
    v_fma_f32 v48, v80, v14, v48
    v_fma_f32 v49, v81, v14, v49
    v_fma_f32 v50, v82, v14, v50
    v_fma_f32 v51, v83, v14, v51
    v_fma_f32 v52, v84, v14, v52
    v_fma_f32 v53, v85, v14, v53
    v_fma_f32 v54, v86, v14, v54
    v_fma_f32 v55, v87, v14, v55
    v_fma_f32 v56, v88, v14, v56
    v_fma_f32 v57, v89, v14, v57
    v_cvt_pk_bf16_f32 v104, v40, v41
    v_cvt_pk_bf16_f32 v105, v42, v43
    v_cvt_pk_bf16_f32 v106, v44, v45
    v_cvt_pk_bf16_f32 v107, v46, v47
    v_cvt_pk_bf16_f32 v108, v48, v49
    v_cvt_pk_bf16_f32 v109, v50, v51
    v_cvt_pk_bf16_f32 v110, v52, v53
    v_cvt_pk_bf16_f32 v111, v54, v55
    v_cvt_pk_bf16_f32 v112, v56, v57
    ds_write_b16 v8, v104 offset:512
    ds_write_b16_d16_hi v8, v104 offset:528
    ds_write_b16 v8, v105 offset:640
    ds_write_b16_d16_hi v8, v105 offset:656
    ds_write_b16 v8, v106 offset:768
    ds_write_b16_d16_hi v8, v106 offset:784
    ds_write_b16 v8, v107 offset:896
    ds_write_b16_d16_hi v8, v107 offset:912
    ds_write_b16 v8, v108 offset:1024
    ds_write_b16_d16_hi v8, v108 offset:1040
    ds_write_b16 v8, v109 offset:1152
    ds_write_b16_d16_hi v8, v109 offset:1168
    ds_write_b16 v8, v110 offset:1280
    ds_write_b16_d16_hi v8, v110 offset:1296
    ds_write_b16 v8, v111 offset:1408
    ds_write_b16_d16_hi v8, v111 offset:1424
    ds_write_b16 v8, v112 offset:1536
    ds_write_b16_d16_hi v8, v112 offset:1552
    v_mov_b32 v4, 4
    v_mov_b32 v5, 1
    ds_write_b32 v4, v5
    s_waitcnt lgkmcnt(0)
    s_add_u32 s82, s83, 1
    s_and_b32 s82, s82, 0xfff
    v_mov_b32 v124, s82
    v_and_b32 v6, 3, v1
    v_lshlrev_b32 v6, 4, v6
    v_bfe_u32 v8, v1, 2, 2
    v_lshlrev_b32 v8, 8, v8
    v_add_u32 v6, v6, v8
    v_lshlrev_b32 v8, 6, v2
    v_add_u32 v6, v6, v8
    v_lshlrev_b32 v7, 4, v1
    s_add_u32 s89, s41, s3
    s_lshl_b32 s88, s89, 13
    s_add_u32 s88, s88, s40
    s_cmp_lt_u32 s3, 2
    s_cbranch_scc1 L_ch_5
    s_sub_u32 s89, s3, 2
    s_lshl_b32 s89, s89, 2
    s_add_u32 s89, s89, 64
    v_mov_b32 v4, s89
    s_mov_b32 s95, 0
L_chs_6:
    ds_read_b32 v5, v4
    s_waitcnt lgkmcnt(0)
    v_readfirstlane_b32 s89, v5
    s_nop 0
    s_cmp_lg_u32 s89, 0
    s_nop 1
    s_cbranch_scc1 L_chsd_7
    s_add_u32 s95, s95, 1
    s_cmp_lt_u32 s95, 1000000
    s_cbranch_scc1 L_chs_6
L_chsd_7:
L_ch_5:
    s_add_u32 s89, s88, 4096
    buffer_load_dwordx4 v[40:43], v6, s[4:7], s88 offen offset:0 nt
    buffer_load_dwordx4 v[44:47], v6, s[4:7], s88 offen offset:1024 nt
    buffer_load_dwordx4 v[48:51], v6, s[4:7], s88 offen offset:2048 nt
    buffer_load_dwordx4 v[52:55], v6, s[4:7], s88 offen offset:3072 nt
    buffer_load_dwordx4 v[56:59], v6, s[4:7], s89 offen offset:0 nt
    buffer_load_dwordx4 v[60:63], v6, s[4:7], s89 offen offset:1024 nt
    buffer_load_dwordx4 v[64:67], v6, s[4:7], s89 offen offset:2048 nt
    buffer_load_dwordx4 v[68:71], v6, s[4:7], s89 offen offset:3072 nt
    buffer_load_dwordx4 v[72:75], v7, s[8:11], s88 offen offset:0 nt
    buffer_load_dwordx4 v[76:79], v7, s[8:11], s88 offen offset:1024 nt
    buffer_load_dwordx4 v[80:83], v7, s[8:11], s88 offen offset:2048 nt
    buffer_load_dwordx4 v[84:87], v7, s[8:11], s88 offen offset:3072 nt
    buffer_load_dwordx4 v[88:91], v7, s[8:11], s89 offen offset:0 nt
    buffer_load_dwordx4 v[92:95], v7, s[8:11], s89 offen offset:1024 nt
    buffer_load_dwordx4 v[96:99], v7, s[8:11], s89 offen offset:2048 nt
    buffer_load_dwordx4 v[100:103], v7, s[8:11], s89 offen offset:3072 nt
    s_waitcnt vmcnt(13)
    s_lshl_b32 s89, s3, 2
    s_add_u32 s89, s89, 64
    v_mov_b32 v4, s89
    v_mov_b32 v5, 1
    ds_write_b32 v4, v5
    v_lshrrev_b32 v6, 5, v1
    v_lshlrev_b32 v7, 11, v6
    v_and_b32 v8, 31, v1
    v_lshlrev_b32 v9, 4, v8
    v_add_u32 v7, v7, v9
    s_lshl_b32 s89, s39, 9
    v_add_u32 v7, s89, v7
    s_lshl_b32 s89, s37, 12
    s_add_u32 s90, s89, 151552
    v_lshlrev_b32 v6, 8, v6
    v_lshlrev_b32 v8, 3, v8
    v_add_u32 v6, v6, v8
    v_and_b32 v8, 7, v1
    s_and_b32 s89, s94, 0xfffffffc
    v_lshlrev_b32 v8, 2, v8
    v_add_u32 v8, s89, v8
    v_lshrrev_b32 v9, 7, v8
    v_lshlrev_b32 v9, 12, v9
    v_and_b32 v8, 127, v8
    v_lshlrev_b32 v8, 2, v8
    v_add_u32 v9, v9, v8
    v_bfe_u32 v8, v1, 3, 1
    v_lshlrev_b32 v8, 9, v8
    v_add_u32 v125, v9, v8
    s_mov_b32 s95, 0
L_qpl_8:
    buffer_load_dwordx4 v[20:23], v7, s[16:19], s90 offen sc1
    buffer_load_dwordx4 v[24:27], v7, s[16:19], s90 offen offset:1024 sc1
    s_waitcnt vmcnt(0)
    v_xor_b32 v10, v124, v20
    v_xor_b32 v11, v124, v21
    v_or_b32 v10, v10, v11
    v_xor_b32 v11, v124, v22
    v_or_b32 v10, v10, v11
    v_xor_b32 v11, v124, v23
    v_or_b32 v10, v10, v11
    v_xor_b32 v11, v124, v24
    v_or_b32 v10, v10, v11
    v_xor_b32 v11, v124, v25
    v_or_b32 v10, v10, v11
    v_xor_b32 v11, v124, v26
    v_or_b32 v10, v10, v11
    v_xor_b32 v11, v124, v27
    v_or_b32 v10, v10, v11
    v_and_b32 v10, s100, v10
    v_cmp_ne_u32 vcc, 0, v10
    s_nop 3
    s_cbranch_vccz L_qpk_9
    s_mov_b64 exec, vcc
    s_sleep 2
    s_add_u32 s95, s95, 1
    s_cmp_lt_u32 s95, 1000000
    s_cbranch_scc1 L_qpl_8
L_qpk_9:
    s_mov_b64 exec, -1
    v_and_b32 v20, 0xfffff000, v20
    v_and_b32 v21, 0xfffff000, v21
    v_and_b32 v22, 0xfffff000, v22
    v_and_b32 v23, 0xfffff000, v23
    v_and_b32 v24, 0xfffff000, v24
    v_and_b32 v25, 0xfffff000, v25
    v_and_b32 v26, 0xfffff000, v26
    v_and_b32 v27, 0xfffff000, v27
    v_add_f32 v20, v20, v24
    v_add_f32 v21, v21, v25
    v_add_f32 v22, v22, v26
    v_add_f32 v23, v23, v27
    v_cvt_pk_bf16_f32 v28, v20, v21
    v_cvt_pk_bf16_f32 v29, v22, v23
    ds_write_b64 v6, v[28:29] offset:2816
    v_mov_b32 v4, 8
    v_mov_b32 v5, 1
    ds_write_b32 v4, v5
    s_mov_b64 exec, 0x1f1f
    s_mov_b32 s90, 4096
    buffer_load_dwordx4 v[108:111], v125, s[16:19], s90 offen offset:0 sc1
    buffer_load_dwordx4 v[112:115], v125, s[16:19], s90 offen offset:1024 sc1
    buffer_load_dwordx4 v[116:119], v125, s[16:19], s90 offen offset:2048 sc1
    buffer_load_dwordx4 v[120:123], v125, s[16:19], s90 offen offset:3072 sc1
    s_mov_b64 exec, -1
    s_branch L_attn_q
L_pre:
    s_cmp_lt_u32 s36, 5
    s_cbranch_scc1 L_pre_c
    s_cmp_lt_u32 s36, 7
    s_cbranch_scc1 L_pre_comb
    s_cmp_eq_u32 s36, 7
    s_cbranch_scc0 L_pre_done
    v_bfe_u32 v108, v3, 2, 1
    v_lshlrev_b32 v108, 3, v108
    v_and_b32 v109, 3, v3
    v_add_u32 v108, v108, v109
    v_lshrrev_b32 v109, 3, v3
    v_lshlrev_b32 v109, 2, v109
    v_add_u32 v108, v108, v109
    v_lshlrev_b32 v108, 11, v108
    v_lshlrev_b32 v109, 5, v2
    v_add_u32 v108, v108, v109
    v_lshlrev_b32 v109, 3, v1
    s_lshl_b32 s85, s37, 15
    s_lshl_b32 s90, s39, 10
    s_add_u32 s85, s85, s90
    s_and_b32 s90, s38, 7
    s_lshl_b32 s90, s90, 7
    s_add_u32 s85, s85, s90
    s_add_u32 s85, s85, 229376
    s_branch L_pre_done
L_pre_comb:
    s_sub_u32 s92, s36, 5
    v_lshlrev_b32 v108, 3, v1
    s_lshl_b32 s89, s92, 9
    v_add_u32 v108, s89, v108
    v_lshlrev_b32 v109, 4, v1
    v_lshlrev_b32 v110, 4, v3
    s_lshl_b32 s89, s92, 3
    v_add_u32 v110, s89, v110
    s_lshl_b32 s85, s2, 11
    s_lshl_b32 s90, s92, 10
    s_add_u32 s85, s85, s90
    s_add_u32 s85, s85, 229376
    s_branch L_pre_done
L_pre_c:
    v_lshrrev_b32 v110, 1, v3
    v_lshlrev_b32 v110, 7, v110
    v_and_b32 v111, 1, v2
    v_lshlrev_b32 v111, 6, v111
    v_add_u32 v110, v110, v111
    v_and_b32 v111, 1, v3
    v_lshlrev_b32 v111, 5, v111
    v_add_u32 v110, v110, v111
    v_lshrrev_b32 v111, 1, v2
    v_lshlrev_b32 v111, 4, v111
    v_add_u32 v110, v110, v111
    v_bfe_u32 v111, v3, 2, 1
    v_lshlrev_b32 v111, 6, v111
    v_lshlrev_b32 v112, 4, v2
    v_add_u32 v111, v111, v112
    v_lshlrev_b32 v112, 3, v1
    v_lshlrev_b32 v108, 4, v1
    s_mul_i32 s89, s36, 9216
    v_add_u32 v108, s89, v108
    s_mul_i32 s85, s2, 4608
    s_lshl_b32 s91, s36, 10
    s_add_u32 s85, s85, s91
    s_add_u32 s85, s85, 753664
L_pre_done:
    v_and_b32 v116, 3, v1
    v_lshlrev_b32 v116, 4, v116
    v_bfe_u32 v6, v1, 2, 2
    v_lshlrev_b32 v6, 8, v6
    v_add_u32 v116, v116, v6
    v_lshlrev_b32 v6, 6, v2
    v_add_u32 v116, v116, v6
    v_lshlrev_b32 v117, 4, v1
L_slot:
    s_add_u32 s89, s41, s3
    s_lshl_b32 s88, s89, 13
    s_add_u32 s88, s88, s40
    s_cmp_lt_u32 s3, 2
    s_cbranch_scc1 L_ch_10
    s_sub_u32 s89, s3, 2
    s_lshl_b32 s89, s89, 2
    s_add_u32 s89, s89, 64
    v_mov_b32 v4, s89
    s_mov_b32 s95, 0
L_chs_11:
    ds_read_b32 v5, v4
    s_waitcnt lgkmcnt(0)
    v_readfirstlane_b32 s89, v5
    s_nop 0
    s_cmp_lg_u32 s89, 0
    s_nop 1
    s_cbranch_scc1 L_chsd_12
    s_add_u32 s95, s95, 1
    s_cmp_lt_u32 s95, 1000000
    s_cbranch_scc1 L_chs_11
L_chsd_12:
L_ch_10:
    s_add_u32 s89, s88, 4096
    buffer_load_dwordx4 v[40:43], v116, s[4:7], s88 offen offset:0 nt
    buffer_load_dwordx4 v[44:47], v116, s[4:7], s88 offen offset:1024 nt
    buffer_load_dwordx4 v[48:51], v116, s[4:7], s88 offen offset:2048 nt
    buffer_load_dwordx4 v[52:55], v116, s[4:7], s88 offen offset:3072 nt
    buffer_load_dwordx4 v[56:59], v116, s[4:7], s89 offen offset:0 nt
    buffer_load_dwordx4 v[60:63], v116, s[4:7], s89 offen offset:1024 nt
    buffer_load_dwordx4 v[64:67], v116, s[4:7], s89 offen offset:2048 nt
    buffer_load_dwordx4 v[68:71], v116, s[4:7], s89 offen offset:3072 nt
    buffer_load_dwordx4 v[72:75], v117, s[8:11], s88 offen offset:0 nt
    buffer_load_dwordx4 v[76:79], v117, s[8:11], s88 offen offset:1024 nt
    buffer_load_dwordx4 v[80:83], v117, s[8:11], s88 offen offset:2048 nt
    buffer_load_dwordx4 v[84:87], v117, s[8:11], s88 offen offset:3072 nt
    buffer_load_dwordx4 v[88:91], v117, s[8:11], s89 offen offset:0 nt
    buffer_load_dwordx4 v[92:95], v117, s[8:11], s89 offen offset:1024 nt
    buffer_load_dwordx4 v[96:99], v117, s[8:11], s89 offen offset:2048 nt
    buffer_load_dwordx4 v[100:103], v117, s[8:11], s89 offen offset:3072 nt
    s_waitcnt vmcnt(13)
    s_lshl_b32 s89, s3, 2
    s_add_u32 s89, s89, 64
    v_mov_b32 v4, s89
    v_mov_b32 v5, 1
    ds_write_b32 v4, v5
    v_mov_b32 v4, 8
    s_mov_b32 s95, 0
L_q_13:
    ds_read_b32 v5, v4
    s_waitcnt lgkmcnt(0)
    v_readfirstlane_b32 s89, v5
    s_nop 0
    s_cmp_ge_u32 s89, 1
    s_nop 1
    s_cbranch_scc1 L_qd_14
    s_sleep 1
    s_add_u32 s95, s95, 1
    s_cmp_lt_u32 s95, 1000000
    s_cbranch_scc1 L_q_13
L_qd_14:
    s_add_u32 s82, s83, 1
    s_and_b32 s82, s82, 0xfff
    v_mov_b32 v124, s82
L_attn_q:
    v_bfe_u32 v6, v3, 2, 1
    v_lshlrev_b32 v6, 8, v6
    v_lshlrev_b32 v7, 6, v2
    v_add_u32 v6, v6, v7
    v_and_b32 v7, 3, v3
    v_lshlrev_b32 v7, 4, v7
    v_add_u32 v6, v6, v7
    ds_read_b128 v[12:15], v6 offset:2816
    s_waitcnt vmcnt(8) lgkmcnt(0)
    v_mfma_f32_16x16x32_bf16 v[40:43], v[40:43], v[12:15], 0
    v_mfma_f32_16x16x32_bf16 v[44:47], v[44:47], v[12:15], 0
    v_mfma_f32_16x16x32_bf16 v[48:51], v[48:51], v[12:15], 0
    v_mfma_f32_16x16x32_bf16 v[52:55], v[52:55], v[12:15], 0
    v_mfma_f32_16x16x32_bf16 v[56:59], v[56:59], v[12:15], 0
    v_mfma_f32_16x16x32_bf16 v[60:63], v[60:63], v[12:15], 0
    v_mfma_f32_16x16x32_bf16 v[64:67], v[64:67], v[12:15], 0
    v_mfma_f32_16x16x32_bf16 v[68:71], v[68:71], v[12:15], 0
    s_nop 0
    v_mov_b32_dpp v28, v40 quad_perm:[0,0,0,0] row_mask:0xf bank_mask:0xf
    v_mov_b32_dpp v29, v44 quad_perm:[0,0,0,0] row_mask:0xf bank_mask:0xf
    v_mov_b32_dpp v30, v48 quad_perm:[0,0,0,0] row_mask:0xf bank_mask:0xf
    v_mov_b32_dpp v31, v52 quad_perm:[0,0,0,0] row_mask:0xf bank_mask:0xf
    v_mov_b32_dpp v32, v56 quad_perm:[0,0,0,0] row_mask:0xf bank_mask:0xf
    v_mov_b32_dpp v33, v60 quad_perm:[0,0,0,0] row_mask:0xf bank_mask:0xf
    v_mov_b32_dpp v34, v64 quad_perm:[0,0,0,0] row_mask:0xf bank_mask:0xf
    v_mov_b32_dpp v35, v68 quad_perm:[0,0,0,0] row_mask:0xf bank_mask:0xf
    v_add_f32_dpp v28, v41, v28 quad_perm:[1,1,1,1] row_mask:0xf bank_mask:0xf
    v_add_f32_dpp v29, v45, v29 quad_perm:[1,1,1,1] row_mask:0xf bank_mask:0xf
    v_add_f32_dpp v30, v49, v30 quad_perm:[1,1,1,1] row_mask:0xf bank_mask:0xf
    v_add_f32_dpp v31, v53, v31 quad_perm:[1,1,1,1] row_mask:0xf bank_mask:0xf
    v_add_f32_dpp v32, v57, v32 quad_perm:[1,1,1,1] row_mask:0xf bank_mask:0xf
    v_add_f32_dpp v33, v61, v33 quad_perm:[1,1,1,1] row_mask:0xf bank_mask:0xf
    v_add_f32_dpp v34, v65, v34 quad_perm:[1,1,1,1] row_mask:0xf bank_mask:0xf
    v_add_f32_dpp v35, v69, v35 quad_perm:[1,1,1,1] row_mask:0xf bank_mask:0xf
    v_add_f32_dpp v28, v42, v28 quad_perm:[2,2,2,2] row_mask:0xf bank_mask:0xf
    v_add_f32_dpp v29, v46, v29 quad_perm:[2,2,2,2] row_mask:0xf bank_mask:0xf
    v_add_f32_dpp v30, v50, v30 quad_perm:[2,2,2,2] row_mask:0xf bank_mask:0xf
    v_add_f32_dpp v31, v54, v31 quad_perm:[2,2,2,2] row_mask:0xf bank_mask:0xf
    v_add_f32_dpp v32, v58, v32 quad_perm:[2,2,2,2] row_mask:0xf bank_mask:0xf
    v_add_f32_dpp v33, v62, v33 quad_perm:[2,2,2,2] row_mask:0xf bank_mask:0xf
    v_add_f32_dpp v34, v66, v34 quad_perm:[2,2,2,2] row_mask:0xf bank_mask:0xf
    v_add_f32_dpp v35, v70, v35 quad_perm:[2,2,2,2] row_mask:0xf bank_mask:0xf
    v_add_f32_dpp v28, v43, v28 quad_perm:[3,3,3,3] row_mask:0xf bank_mask:0xf
    v_add_f32_dpp v29, v47, v29 quad_perm:[3,3,3,3] row_mask:0xf bank_mask:0xf
    v_add_f32_dpp v30, v51, v30 quad_perm:[3,3,3,3] row_mask:0xf bank_mask:0xf
    v_add_f32_dpp v31, v55, v31 quad_perm:[3,3,3,3] row_mask:0xf bank_mask:0xf
    v_add_f32_dpp v32, v59, v32 quad_perm:[3,3,3,3] row_mask:0xf bank_mask:0xf
    v_add_f32_dpp v33, v63, v33 quad_perm:[3,3,3,3] row_mask:0xf bank_mask:0xf
    v_add_f32_dpp v34, v67, v34 quad_perm:[3,3,3,3] row_mask:0xf bank_mask:0xf
    v_add_f32_dpp v35, v71, v35 quad_perm:[3,3,3,3] row_mask:0xf bank_mask:0xf
    v_cvt_pk_bf16_f32 v36, v28, v29
    v_cvt_pk_bf16_f32 v37, v30, v31
    v_cvt_pk_bf16_f32 v38, v32, v33
    v_cvt_pk_bf16_f32 v39, v34, v35
    v_lshlrev_b32 v28, 16, v36
    v_and_b32 v29, 0xffff0000, v36
    v_lshlrev_b32 v30, 16, v37
    v_and_b32 v31, 0xffff0000, v37
    v_lshlrev_b32 v32, 16, v38
    v_and_b32 v33, 0xffff0000, v38
    v_lshlrev_b32 v34, 16, v39
    v_and_b32 v35, 0xffff0000, v39
    s_mov_b32 s89, 0x3db504f3
    v_mul_f32 v28, s89, v28
    v_mul_f32 v29, s89, v29
    v_mul_f32 v30, s89, v30
    v_mul_f32 v31, s89, v31
    v_mul_f32 v32, s89, v32
    v_mul_f32 v33, s89, v33
    v_mul_f32 v34, s89, v34
    v_mul_f32 v35, s89, v35
    v_cvt_pk_bf16_f32 v36, v28, v29
    v_cvt_pk_bf16_f32 v37, v30, v31
    v_cvt_pk_bf16_f32 v38, v32, v33
    v_cvt_pk_bf16_f32 v39, v34, v35
    v_lshlrev_b32 v28, 16, v36
    v_and_b32 v29, 0xffff0000, v36
    v_lshlrev_b32 v30, 16, v37
    v_and_b32 v31, 0xffff0000, v37
    v_lshlrev_b32 v32, 16, v38
    v_and_b32 v33, 0xffff0000, v38
    v_lshlrev_b32 v34, 16, v39
    v_and_b32 v35, 0xffff0000, v39
    v_max3_f32 v104, v28, v29, v30
    v_max3_f32 v105, v31, v32, v33
    v_max3_f32 v104, v104, v34, v35
    v_max_f32 v104, v104, v105
    v_mov_b32 v6, v104
    s_nop 1
    v_permlane16_swap_b32 v6, v104
    v_max_f32 v104, v104, v6
    v_mov_b32 v6, v104
    s_nop 1
    v_permlane32_swap_b32 v6, v104
    v_max_f32 v104, v104, v6
    s_mov_b32 s89, 0x3fb8aa3b
    v_mul_f32 v7, s89, v104
    v_fma_f32 v28, v28, s89, -v7
    v_fma_f32 v29, v29, s89, -v7
    v_fma_f32 v30, v30, s89, -v7
    v_fma_f32 v31, v31, s89, -v7
    v_fma_f32 v32, v32, s89, -v7
    v_fma_f32 v33, v33, s89, -v7
    v_fma_f32 v34, v34, s89, -v7
    v_fma_f32 v35, v35, s89, -v7
    v_exp_f32 v28, v28
    v_exp_f32 v29, v29
    v_exp_f32 v30, v30
    v_exp_f32 v31, v31
    v_exp_f32 v32, v32
    v_exp_f32 v33, v33
    v_exp_f32 v34, v34
    v_exp_f32 v35, v35
    v_cvt_pk_bf16_f32 v36, v28, v29
    v_cvt_pk_bf16_f32 v37, v30, v31
    v_cvt_pk_bf16_f32 v38, v32, v33
    v_cvt_pk_bf16_f32 v39, v34, v35
    v_add_f32 v28, v28, v32
    v_add_f32 v29, v29, v33
    v_add_f32 v30, v30, v34
    v_add_f32 v31, v31, v35
    v_add_f32 v28, v28, v30
    v_add_f32 v29, v29, v31
    v_add_f32 v105, v28, v29
    v_mov_b32 v6, v105
    s_nop 1
    v_permlane16_swap_b32 v6, v105
    v_add_f32 v105, v105, v6
    v_mov_b32 v6, v105
    s_nop 1
    v_permlane32_swap_b32 v6, v105
    v_add_f32 v105, v105, v6
    v_bfe_u32 v9, v3, 2, 1
    v_lshlrev_b32 v9, 3, v9
    s_lshl_b32 s89, s3, 4
    v_add_u32 v9, s89, v9
    s_mov_b64 exec, 0x11
    ds_write_b64 v9, v[104:105] offset:3456
    v_mov_b32 v4, 20
    v_mov_b32 v5, 1
    s_mov_b64 exec, 1
    ds_add_u32 v4, v5
    s_mov_b64 exec, -1
    v_cndmask_b32_e64 v40, 0, v36, s[64:65]
    v_cndmask_b32_e64 v41, 0, v37, s[64:65]
    v_cndmask_b32_e64 v42, 0, v38, s[64:65]
    v_cndmask_b32_e64 v43, 0, v39, s[64:65]
    v_cndmask_b32_e64 v44, 0, v36, s[66:67]
    v_cndmask_b32_e64 v45, 0, v37, s[66:67]
    v_cndmask_b32_e64 v46, 0, v38, s[66:67]
    v_cndmask_b32_e64 v47, 0, v39, s[66:67]
    v_cndmask_b32_e64 v48, 0, v36, s[68:69]
    v_cndmask_b32_e64 v49, 0, v37, s[68:69]
    v_cndmask_b32_e64 v50, 0, v38, s[68:69]
    v_cndmask_b32_e64 v51, 0, v39, s[68:69]
    v_cndmask_b32_e64 v52, 0, v36, s[70:71]
    v_cndmask_b32_e64 v53, 0, v37, s[70:71]
    v_cndmask_b32_e64 v54, 0, v38, s[70:71]
    v_cndmask_b32_e64 v55, 0, v39, s[70:71]
    v_cndmask_b32_e64 v56, 0, v36, s[72:73]
    v_cndmask_b32_e64 v57, 0, v37, s[72:73]
    v_cndmask_b32_e64 v58, 0, v38, s[72:73]
    v_cndmask_b32_e64 v59, 0, v39, s[72:73]
    v_cndmask_b32_e64 v60, 0, v36, s[74:75]
    v_cndmask_b32_e64 v61, 0, v37, s[74:75]
    v_cndmask_b32_e64 v62, 0, v38, s[74:75]
    v_cndmask_b32_e64 v63, 0, v39, s[74:75]
    v_cndmask_b32_e64 v64, 0, v36, s[76:77]
    v_cndmask_b32_e64 v65, 0, v37, s[76:77]
    v_cndmask_b32_e64 v66, 0, v38, s[76:77]
    v_cndmask_b32_e64 v67, 0, v39, s[76:77]
    v_cndmask_b32_e64 v68, 0, v36, s[78:79]
    v_cndmask_b32_e64 v69, 0, v37, s[78:79]
    v_cndmask_b32_e64 v70, 0, v38, s[78:79]
    v_cndmask_b32_e64 v71, 0, v39, s[78:79]
    v_and_b32 v8, 1, v2
    v_lshlrev_b32 v8, 9, v8
    v_lshlrev_b32 v7, 5, v3
    v_add_u32 v8, v8, v7
    v_lshrrev_b32 v7, 1, v2
    v_lshlrev_b32 v7, 4, v7
    v_add_u32 v8, v8, v7
    s_lshl_b32 s89, s3, 10
    v_add_u32 v8, s89, v8
    s_waitcnt vmcnt(0)
    v_perm_b32 v20, v76, v72, s80
    v_perm_b32 v21, v84, v80, s80
    v_perm_b32 v22, v92, v88, s80
    v_perm_b32 v23, v100, v96, s80
    s_nop 1
    v_mfma_f32_16x16x32_bf16 v[16:19], v[40:43], v[20:23], 0
    v_perm_b32 v24, v76, v72, s81
    v_perm_b32 v25, v84, v80, s81
    v_perm_b32 v26, v92, v88, s81
    v_perm_b32 v27, v100, v96, s81
    s_nop 1
    v_mfma_f32_16x16x32_bf16 v[16:19], v[44:47], v[24:27], v[16:19]
    v_perm_b32 v20, v77, v73, s80
    v_perm_b32 v21, v85, v81, s80
    v_perm_b32 v22, v93, v89, s80
    v_perm_b32 v23, v101, v97, s80
    s_nop 1
    v_mfma_f32_16x16x32_bf16 v[16:19], v[48:51], v[20:23], v[16:19]
    v_perm_b32 v24, v77, v73, s81
    v_perm_b32 v25, v85, v81, s81
    v_perm_b32 v26, v93, v89, s81
    v_perm_b32 v27, v101, v97, s81
    s_nop 1
    v_mfma_f32_16x16x32_bf16 v[16:19], v[52:55], v[24:27], v[16:19]
    v_perm_b32 v20, v78, v74, s80
    v_perm_b32 v21, v86, v82, s80
    v_perm_b32 v22, v94, v90, s80
    v_perm_b32 v23, v102, v98, s80
    s_nop 1
    v_mfma_f32_16x16x32_bf16 v[16:19], v[56:59], v[20:23], v[16:19]
    v_perm_b32 v24, v78, v74, s81
    v_perm_b32 v25, v86, v82, s81
    v_perm_b32 v26, v94, v90, s81
    v_perm_b32 v27, v102, v98, s81
    s_nop 1
    v_mfma_f32_16x16x32_bf16 v[16:19], v[60:63], v[24:27], v[16:19]
    v_perm_b32 v20, v79, v75, s80
    v_perm_b32 v21, v87, v83, s80
    v_perm_b32 v22, v95, v91, s80
    v_perm_b32 v23, v103, v99, s80
    s_nop 1
    v_mfma_f32_16x16x32_bf16 v[16:19], v[64:67], v[20:23], v[16:19]
    v_perm_b32 v24, v79, v75, s81
    v_perm_b32 v25, v87, v83, s81
    v_perm_b32 v26, v95, v91, s81
    v_perm_b32 v27, v103, v99, s81
    s_nop 1
    v_mfma_f32_16x16x32_bf16 v[16:19], v[68:71], v[24:27], v[16:19]
    s_nop 7
    ds_write_b128 v8, v[16:19] offset:16384
    s_cmp_eq_u32 s36, 15
    s_cbranch_scc1 L_hfin
    s_cmp_lg_u32 s3, 15
    s_cbranch_scc1 L_tiles_done
L_tiles_done:
    s_waitcnt lgkmcnt(0)
    s_add_u32 s82, s83, 1
    s_and_b32 s82, s82, 0xfff
    v_mov_b32 v124, s82
    s_cmp_lt_u32 s36, 12
    s_cbranch_scc1 L_noiss
    s_cmp_gt_u32 s36, 14
    s_cbranch_scc1 L_noiss
    v_lshlrev_b32 v7, 4, v3
    v_mul_u32_u24 v6, 1152, v2
    v_add_u32 v6, v6, v7
    v_mul_u32_u24 v10, 4608, v2
    v_add_u32 v10, v10, v7
    s_lshl_b32 s91, s2, 4
    s_mul_i32 s87, s91, 1152
    s_mul_i32 s86, s94, 1152
    v_mov_b32 v4, 124
    s_mov_b32 s95, 0
L_ce_15:
    ds_read_b32 v5, v4
    s_waitcnt lgkmcnt(0)
    v_readfirstlane_b32 s89, v5
    s_nop 0
    s_cmp_lg_u32 s89, 0
    s_nop 1
    s_cbranch_scc1 L_ced_16
    s_sleep 1
    s_add_u32 s95, s95, 1
    s_cmp_lt_u32 s95, 1000000
    s_cbranch_scc1 L_ce_15
L_ced_16:
    s_cmp_lg_u32 s36, 12
    s_cbranch_scc1 L_cnext_17
    s_mov_b64 exec, -1
    s_add_u32 s91, s87, 0
    s_mov_b32 m0, 40960
    s_nop 0
    buffer_load_dwordx4 v10, s[20:23], s91 offen nt lds
    s_add_u32 s91, s87, 1152
    s_mov_b32 m0, 41984
    s_nop 0
    buffer_load_dwordx4 v10, s[20:23], s91 offen nt lds
    s_add_u32 s91, s87, 2304
    s_mov_b32 m0, 43008
    s_nop 0
    buffer_load_dwordx4 v10, s[20:23], s91 offen nt lds
    s_add_u32 s91, s87, 3456
    s_mov_b32 m0, 44032
    s_nop 0
    buffer_load_dwordx4 v10, s[20:23], s91 offen nt lds
    s_add_u32 s91, s86, 0
    s_mov_b32 m0, 45056
    s_nop 0
    buffer_load_dwordx4 v6, s[24:27], s91 offen nt lds
    s_add_u32 s91, s86, 4608
    s_mov_b32 m0, 46080
    s_nop 0
    buffer_load_dwordx4 v6, s[24:27], s91 offen nt lds
    s_add_u32 s91, s86, 9216
    s_mov_b32 m0, 47104
    s_nop 0
    buffer_load_dwordx4 v6, s[24:27], s91 offen nt lds
    s_add_u32 s91, s86, 13824
    s_mov_b32 m0, 48128
    s_nop 0
    buffer_load_dwordx4 v6, s[24:27], s91 offen nt lds
    s_mov_b32 exec_lo, 0xffffffff
    s_mov_b32 exec_hi, 0x0
    s_add_u32 s91, s86, 18432
    s_mov_b32 m0, 49152
    s_nop 0
    buffer_load_dwordx4 v6, s[24:27], s91 offen nt lds
    s_mov_b64 exec, -1
    s_add_u32 s91, s87, 256
    s_mov_b32 m0, 50176
    s_nop 0
    buffer_load_dwordx4 v10, s[20:23], s91 offen nt lds
    s_add_u32 s91, s87, 1408
    s_mov_b32 m0, 51200
    s_nop 0
    buffer_load_dwordx4 v10, s[20:23], s91 offen nt lds
    s_add_u32 s91, s87, 2560
    s_mov_b32 m0, 52224
    s_nop 0
    buffer_load_dwordx4 v10, s[20:23], s91 offen nt lds
    s_add_u32 s91, s87, 3712
    s_mov_b32 m0, 53248
    s_nop 0
    buffer_load_dwordx4 v10, s[20:23], s91 offen nt lds
    s_add_u32 s91, s86, 256
    s_mov_b32 m0, 54272
    s_nop 0
    buffer_load_dwordx4 v6, s[24:27], s91 offen nt lds
    s_add_u32 s91, s86, 4864
    s_mov_b32 m0, 55296
    s_nop 0
    buffer_load_dwordx4 v6, s[24:27], s91 offen nt lds
    s_mov_b64 exec, -1
    s_branch L_noiss
L_cnext_17:
    s_cmp_lg_u32 s36, 13
    s_cbranch_scc1 L_cnext_18
    s_mov_b64 exec, -1
    s_add_u32 s91, s86, 9472
    s_mov_b32 m0, 56320
    s_nop 0
    buffer_load_dwordx4 v6, s[24:27], s91 offen nt lds
    s_add_u32 s91, s86, 14080
    s_mov_b32 m0, 57344
    s_nop 0
    buffer_load_dwordx4 v6, s[24:27], s91 offen nt lds
    s_mov_b32 exec_lo, 0xffffffff
    s_mov_b32 exec_hi, 0x0
    s_add_u32 s91, s86, 18688
    s_mov_b32 m0, 58368
    s_nop 0
    buffer_load_dwordx4 v6, s[24:27], s91 offen nt lds
    s_mov_b64 exec, -1
    s_add_u32 s91, s87, 512
    s_mov_b32 m0, 59392
    s_nop 0
    buffer_load_dwordx4 v10, s[20:23], s91 offen nt lds
    s_add_u32 s91, s87, 1664
    s_mov_b32 m0, 60416
    s_nop 0
    buffer_load_dwordx4 v10, s[20:23], s91 offen nt lds
    s_add_u32 s91, s87, 2816
    s_mov_b32 m0, 61440
    s_nop 0
    buffer_load_dwordx4 v10, s[20:23], s91 offen nt lds
    s_add_u32 s91, s87, 3968
    s_mov_b32 m0, 62464
    s_nop 0
    buffer_load_dwordx4 v10, s[20:23], s91 offen nt lds
    s_add_u32 s91, s86, 512
    s_mov_b32 m0, 63488
    s_nop 0
    buffer_load_dwordx4 v6, s[24:27], s91 offen nt lds
    s_add_u32 s91, s86, 5120
    s_mov_b32 m0, 64512
    s_nop 0
    buffer_load_dwordx4 v6, s[24:27], s91 offen nt lds
    s_add_u32 s91, s86, 9728
    s_mov_b32 m0, 65536
    s_nop 0
    buffer_load_dwordx4 v6, s[24:27], s91 offen nt lds
    s_add_u32 s91, s86, 14336
    s_mov_b32 m0, 66560
    s_nop 0
    buffer_load_dwordx4 v6, s[24:27], s91 offen nt lds
    s_mov_b32 exec_lo, 0xffffffff
    s_mov_b32 exec_hi, 0x0
    s_add_u32 s91, s86, 18944
    s_mov_b32 m0, 67584
    s_nop 0
    buffer_load_dwordx4 v6, s[24:27], s91 offen nt lds
    s_mov_b64 exec, -1
    s_add_u32 s91, s87, 768
    s_mov_b32 m0, 68608
    s_nop 0
    buffer_load_dwordx4 v10, s[20:23], s91 offen nt lds
    s_add_u32 s91, s87, 1920
    s_mov_b32 m0, 69632
    s_nop 0
    buffer_load_dwordx4 v10, s[20:23], s91 offen nt lds
    s_add_u32 s91, s87, 3072
    s_mov_b32 m0, 70656
    s_nop 0
    buffer_load_dwordx4 v10, s[20:23], s91 offen nt lds
    s_mov_b64 exec, -1
    s_branch L_noiss
L_cnext_18:
    s_cmp_lg_u32 s36, 14
    s_cbranch_scc1 L_cnext_19
    s_mov_b64 exec, -1
    s_add_u32 s91, s87, 4224
    s_mov_b32 m0, 71680
    s_nop 0
    buffer_load_dwordx4 v10, s[20:23], s91 offen nt lds
    s_add_u32 s91, s86, 768
    s_mov_b32 m0, 72704
    s_nop 0
    buffer_load_dwordx4 v6, s[24:27], s91 offen nt lds
    s_add_u32 s91, s86, 5376
    s_mov_b32 m0, 73728
    s_nop 0
    buffer_load_dwordx4 v6, s[24:27], s91 offen nt lds
    s_add_u32 s91, s86, 9984
    s_mov_b32 m0, 74752
    s_nop 0
    buffer_load_dwordx4 v6, s[24:27], s91 offen nt lds
    s_add_u32 s91, s86, 14592
    s_mov_b32 m0, 75776
    s_nop 0
    buffer_load_dwordx4 v6, s[24:27], s91 offen nt lds
    s_mov_b32 exec_lo, 0xffffffff
    s_mov_b32 exec_hi, 0x0
    s_add_u32 s91, s86, 19200
    s_mov_b32 m0, 76800
    s_nop 0
    buffer_load_dwordx4 v6, s[24:27], s91 offen nt lds
    s_mov_b32 exec_lo, 0xff00ff
    s_mov_b32 exec_hi, 0xff00ff
    s_add_u32 s91, s87, 1024
    s_mov_b32 m0, 77824
    s_nop 0
    buffer_load_dwordx4 v10, s[20:23], s91 offen nt lds
    s_add_u32 s91, s87, 2176
    s_mov_b32 m0, 78848
    s_nop 0
    buffer_load_dwordx4 v10, s[20:23], s91 offen nt lds
    s_add_u32 s91, s87, 3328
    s_mov_b32 m0, 79872
    s_nop 0
    buffer_load_dwordx4 v10, s[20:23], s91 offen nt lds
    s_add_u32 s91, s87, 4480
    s_mov_b32 m0, 80896
    s_nop 0
    buffer_load_dwordx4 v10, s[20:23], s91 offen nt lds
    s_add_u32 s91, s86, 1024
    s_mov_b32 m0, 81920
    s_nop 0
    buffer_load_dwordx4 v6, s[24:27], s91 offen nt lds
    s_add_u32 s91, s86, 5632
    s_mov_b32 m0, 82944
    s_nop 0
    buffer_load_dwordx4 v6, s[24:27], s91 offen nt lds
    s_add_u32 s91, s86, 10240
    s_mov_b32 m0, 83968
    s_nop 0
    buffer_load_dwordx4 v6, s[24:27], s91 offen nt lds
    s_add_u32 s91, s86, 14848
    s_mov_b32 m0, 84992
    s_nop 0
    buffer_load_dwordx4 v6, s[24:27], s91 offen nt lds
    s_mov_b32 exec_lo, 0xff00ff
    s_mov_b32 exec_hi, 0x0
    s_add_u32 s91, s86, 19456
    s_mov_b32 m0, 86016
    s_nop 0
    buffer_load_dwordx4 v6, s[24:27], s91 offen nt lds
    s_mov_b64 exec, -1
    s_branch L_noiss
L_cnext_19:
L_noiss:
    s_sub_u32 s89, s36, 5
    s_cmp_lt_u32 s89, 2
    s_cbranch_scc0 L_nowt
    v_mov_b32 v4, 20
    s_mov_b32 s95, 0
L_st_20:
    ds_read_b32 v5, v4
    s_waitcnt lgkmcnt(0)
    v_readfirstlane_b32 s89, v5
    s_nop 0
    s_cmp_ge_u32 s89, 16
    s_nop 1
    s_cbranch_scc1 L_std_21
    s_add_u32 s95, s95, 1
    s_cmp_lt_u32 s95, 1000000
    s_cbranch_scc1 L_st_20
L_std_21:
    ds_read_b64 v[12:13], v110 offset:3456
    ds_read_b64 v[14:15], v110 offset:3712
    s_waitcnt lgkmcnt(0)
    v_max_f32 v113, v12, v14
    s_nop 1
    v_max_f32_dpp v113, v113, v113 quad_perm:[1,0,3,2] row_mask:0xf bank_mask:0xf
    s_nop 1
    v_max_f32_dpp v113, v113, v113 quad_perm:[2,3,0,1] row_mask:0xf bank_mask:0xf
    s_nop 1
    v_max_f32_dpp v113, v113, v113 row_half_mirror row_mask:0xf bank_mask:0xf
    s_nop 1
    v_max_f32_dpp v113, v113, v113 row_mirror row_mask:0xf bank_mask:0xf
    s_mov_b32 s89, 0x3fb8aa3b
    v_sub_f32 v111, v12, v113
    v_sub_f32 v112, v14, v113
    v_mul_f32 v111, s89, v111
    v_mul_f32 v112, s89, v112
    v_exp_f32 v111, v111
    v_exp_f32 v112, v112
    v_mul_f32 v114, v13, v111
    v_fmac_f32 v114, v15, v112
    s_nop 1
    v_add_f32_dpp v114, v114, v114 quad_perm:[1,0,3,2] row_mask:0xf bank_mask:0xf
    s_nop 1
    v_add_f32_dpp v114, v114, v114 quad_perm:[2,3,0,1] row_mask:0xf bank_mask:0xf
    s_nop 1
    v_add_f32_dpp v114, v114, v114 row_half_mirror row_mask:0xf bank_mask:0xf
    s_nop 1
    v_add_f32_dpp v114, v114, v114 row_mirror row_mask:0xf bank_mask:0xf
    v_add_u32 v113, 0x800, v113
    v_add_u32 v114, 0x800, v114
    v_bfi_b32 v113, s100, v124, v113
    v_bfi_b32 v114, s100, v124, v114
L_nowt:
    s_nop 0
    s_branch L_noh
L_hfin:
    s_mov_b64 exec, 0x1f1f
    s_mov_b32 s95, 0
    s_branch L_hchk
L_hpoll:
    s_mov_b32 s90, 4096
    buffer_load_dwordx4 v[108:111], v125, s[16:19], s90 offen offset:0 sc1
    buffer_load_dwordx4 v[112:115], v125, s[16:19], s90 offen offset:1024 sc1
    buffer_load_dwordx4 v[116:119], v125, s[16:19], s90 offen offset:2048 sc1
    buffer_load_dwordx4 v[120:123], v125, s[16:19], s90 offen offset:3072 sc1
    s_waitcnt vmcnt(0)
L_hchk:
    v_xor_b32 v10, v124, v108
    v_xor_b32 v11, v124, v109
    v_or_b32 v10, v10, v11
    v_xor_b32 v11, v124, v110
    v_or_b32 v10, v10, v11
    v_xor_b32 v11, v124, v111
    v_or_b32 v10, v10, v11
    v_xor_b32 v11, v124, v112
    v_or_b32 v10, v10, v11
    v_xor_b32 v11, v124, v113
    v_or_b32 v10, v10, v11
    v_xor_b32 v11, v124, v114
    v_or_b32 v10, v10, v11
    v_xor_b32 v11, v124, v115
    v_or_b32 v10, v10, v11
    v_xor_b32 v11, v124, v116
    v_or_b32 v10, v10, v11
    v_xor_b32 v11, v124, v117
    v_or_b32 v10, v10, v11
    v_xor_b32 v11, v124, v118
    v_or_b32 v10, v10, v11
    v_xor_b32 v11, v124, v119
    v_or_b32 v10, v10, v11
    v_xor_b32 v11, v124, v120
    v_or_b32 v10, v10, v11
    v_xor_b32 v11, v124, v121
    v_or_b32 v10, v10, v11
    v_xor_b32 v11, v124, v122
    v_or_b32 v10, v10, v11
    v_xor_b32 v11, v124, v123
    v_or_b32 v10, v10, v11
    v_and_b32 v10, s100, v10
    v_cmp_ne_u32 vcc, 0, v10
    s_nop 3
    s_cbranch_vccz L_hok
    s_sleep 1
    s_add_u32 s95, s95, 1
    s_cmp_lt_u32 s95, 1000000
    s_cbranch_scc1 L_hpoll
L_hok:
    v_and_b32 v108, 0xfffff000, v108
    v_and_b32 v109, 0xfffff000, v109
    v_and_b32 v110, 0xfffff000, v110
    v_and_b32 v111, 0xfffff000, v111
    v_and_b32 v112, 0xfffff000, v112
    v_and_b32 v113, 0xfffff000, v113
    v_and_b32 v114, 0xfffff000, v114
    v_and_b32 v115, 0xfffff000, v115
    v_and_b32 v116, 0xfffff000, v116
    v_and_b32 v117, 0xfffff000, v117
    v_and_b32 v118, 0xfffff000, v118
    v_and_b32 v119, 0xfffff000, v119
    v_and_b32 v120, 0xfffff000, v120
    v_and_b32 v121, 0xfffff000, v121
    v_and_b32 v122, 0xfffff000, v122
    v_and_b32 v123, 0xfffff000, v123
    s_and_b32 s89, s94, 3
    v_and_b32 v6, 7, v1
    v_lshlrev_b32 v8, 2, v6
    v_subrev_u32 v8, s89, v8
    v_bfe_u32 v7, v1, 3, 1
    v_lshlrev_b32 v7, 6, v7
    v_add_u32 v7, 3328, v7
    v_mov_b32 v9, 60
    v_add_f32 v108, v108, v112
    v_add_f32 v116, v116, v120
    v_cvt_pk_bf16_f32 v108, v108, v108
    v_lshlrev_b32 v108, 16, v108
    v_cvt_pk_bf16_f32 v116, v116, v116
    v_lshlrev_b32 v116, 16, v116
    v_mul_f32 v108, v108, v116
    v_cvt_pk_bf16_f32 v108, v108, v108
    v_add_u32 v10, 0, v8
    v_and_b32 v11, 3, v10
    v_lshlrev_b32 v11, 4, v11
    v_add_u32 v11, v11, v7
    v_lshrrev_b32 v116, 2, v10
    v_lshlrev_b32 v116, 1, v116
    v_add_u32 v11, v11, v116
    v_cmp_gt_u32 vcc, 18, v10
    s_nop 1
    v_cndmask_b32 v11, v9, v11, vcc
    ds_write_b16 v11, v108
    v_add_f32 v109, v109, v113
    v_add_f32 v117, v117, v121
    v_cvt_pk_bf16_f32 v109, v109, v109
    v_lshlrev_b32 v109, 16, v109
    v_cvt_pk_bf16_f32 v117, v117, v117
    v_lshlrev_b32 v117, 16, v117
    v_mul_f32 v109, v109, v117
    v_cvt_pk_bf16_f32 v109, v109, v109
    v_add_u32 v10, 1, v8
    v_and_b32 v11, 3, v10
    v_lshlrev_b32 v11, 4, v11
    v_add_u32 v11, v11, v7
    v_lshrrev_b32 v117, 2, v10
    v_lshlrev_b32 v117, 1, v117
    v_add_u32 v11, v11, v117
    v_cmp_gt_u32 vcc, 18, v10
    s_nop 1
    v_cndmask_b32 v11, v9, v11, vcc
    ds_write_b16 v11, v109
    v_add_f32 v110, v110, v114
    v_add_f32 v118, v118, v122
    v_cvt_pk_bf16_f32 v110, v110, v110
    v_lshlrev_b32 v110, 16, v110
    v_cvt_pk_bf16_f32 v118, v118, v118
    v_lshlrev_b32 v118, 16, v118
    v_mul_f32 v110, v110, v118
    v_cvt_pk_bf16_f32 v110, v110, v110
    v_add_u32 v10, 2, v8
    v_and_b32 v11, 3, v10
    v_lshlrev_b32 v11, 4, v11
    v_add_u32 v11, v11, v7
    v_lshrrev_b32 v118, 2, v10
    v_lshlrev_b32 v118, 1, v118
    v_add_u32 v11, v11, v118
    v_cmp_gt_u32 vcc, 18, v10
    s_nop 1
    v_cndmask_b32 v11, v9, v11, vcc
    ds_write_b16 v11, v110
    v_add_f32 v111, v111, v115
    v_add_f32 v119, v119, v123
    v_cvt_pk_bf16_f32 v111, v111, v111
    v_lshlrev_b32 v111, 16, v111
    v_cvt_pk_bf16_f32 v119, v119, v119
    v_lshlrev_b32 v119, 16, v119
    v_mul_f32 v111, v111, v119
    v_cvt_pk_bf16_f32 v111, v111, v111
    v_add_u32 v10, 3, v8
    v_and_b32 v11, 3, v10
    v_lshlrev_b32 v11, 4, v11
    v_add_u32 v11, v11, v7
    v_lshrrev_b32 v119, 2, v10
    v_lshlrev_b32 v119, 1, v119
    v_add_u32 v11, v11, v119
    v_cmp_gt_u32 vcc, 18, v10
    s_nop 1
    v_cndmask_b32 v11, v9, v11, vcc
    ds_write_b16 v11, v111
    s_mov_b64 exec, -1
L_noh:
    s_waitcnt lgkmcnt(0)
    s_barrier
    s_cmp_lt_u32 s36, 5
    s_cbranch_scc1 L_stagec
    s_cmp_eq_u32 s36, 7
    s_cbranch_scc1 L_ogather
    s_cmp_lt_u32 s36, 7
    s_cbranch_scc1 L_combine
    s_cmp_lt_u32 s36, 12
    s_cbranch_scc1 L_final
    s_cmp_gt_u32 s36, 14
    s_cbranch_scc1 L_final
    s_waitcnt vmcnt(0)
    v_mov_b32 v4, 12
    v_mov_b32 v5, 1
    s_mov_b64 exec, 1
    ds_add_u32 v4, v5
    s_mov_b64 exec, -1
    s_branch L_final
L_combine:
    ds_read_b64 v[40:41], v108 offset:16384
    ds_read_b64 v[42:43], v108 offset:17408
    ds_read_b64 v[44:45], v108 offset:18432
    ds_read_b64 v[46:47], v108 offset:19456
    ds_read_b64 v[48:49], v108 offset:20480
    ds_read_b64 v[50:51], v108 offset:21504
    ds_read_b64 v[52:53], v108 offset:22528
    ds_read_b64 v[54:55], v108 offset:23552
    ds_read_b64 v[56:57], v108 offset:24576
    ds_read_b64 v[58:59], v108 offset:25600
    ds_read_b64 v[60:61], v108 offset:26624
    ds_read_b64 v[62:63], v108 offset:27648
    ds_read_b64 v[64:65], v108 offset:28672
    ds_read_b64 v[66:67], v108 offset:29696
    ds_read_b64 v[68:69], v108 offset:30720
    ds_read_b64 v[70:71], v108 offset:31744
    v_mov_b32 v18, v113
    v_mov_b32 v19, v114
    s_waitcnt lgkmcnt(8)
    v_mul_f32_dpp v16, v111, v40 row_newbcast:0 row_mask:0xf bank_mask:0xf
    v_mul_f32_dpp v17, v111, v41 row_newbcast:0 row_mask:0xf bank_mask:0xf
    v_mul_f32_dpp v12, v111, v42 row_newbcast:1 row_mask:0xf bank_mask:0xf
    v_mul_f32_dpp v13, v111, v43 row_newbcast:1 row_mask:0xf bank_mask:0xf
    v_fmac_f32_dpp v16, v111, v44 row_newbcast:2 row_mask:0xf bank_mask:0xf
    v_fmac_f32_dpp v17, v111, v45 row_newbcast:2 row_mask:0xf bank_mask:0xf
    v_fmac_f32_dpp v12, v111, v46 row_newbcast:3 row_mask:0xf bank_mask:0xf
    v_fmac_f32_dpp v13, v111, v47 row_newbcast:3 row_mask:0xf bank_mask:0xf
    v_fmac_f32_dpp v16, v111, v48 row_newbcast:4 row_mask:0xf bank_mask:0xf
    v_fmac_f32_dpp v17, v111, v49 row_newbcast:4 row_mask:0xf bank_mask:0xf
    v_fmac_f32_dpp v12, v111, v50 row_newbcast:5 row_mask:0xf bank_mask:0xf
    v_fmac_f32_dpp v13, v111, v51 row_newbcast:5 row_mask:0xf bank_mask:0xf
    v_fmac_f32_dpp v16, v111, v52 row_newbcast:6 row_mask:0xf bank_mask:0xf
    v_fmac_f32_dpp v17, v111, v53 row_newbcast:6 row_mask:0xf bank_mask:0xf
    v_fmac_f32_dpp v12, v111, v54 row_newbcast:7 row_mask:0xf bank_mask:0xf
    v_fmac_f32_dpp v13, v111, v55 row_newbcast:7 row_mask:0xf bank_mask:0xf
    s_waitcnt lgkmcnt(0)
    v_fmac_f32_dpp v16, v111, v56 row_newbcast:8 row_mask:0xf bank_mask:0xf
    v_fmac_f32_dpp v17, v111, v57 row_newbcast:8 row_mask:0xf bank_mask:0xf
    v_fmac_f32_dpp v12, v111, v58 row_newbcast:9 row_mask:0xf bank_mask:0xf
    v_fmac_f32_dpp v13, v111, v59 row_newbcast:9 row_mask:0xf bank_mask:0xf
    v_fmac_f32_dpp v16, v111, v60 row_newbcast:10 row_mask:0xf bank_mask:0xf
    v_fmac_f32_dpp v17, v111, v61 row_newbcast:10 row_mask:0xf bank_mask:0xf
    v_fmac_f32_dpp v12, v111, v62 row_newbcast:11 row_mask:0xf bank_mask:0xf
    v_fmac_f32_dpp v13, v111, v63 row_newbcast:11 row_mask:0xf bank_mask:0xf
    v_fmac_f32_dpp v16, v111, v64 row_newbcast:12 row_mask:0xf bank_mask:0xf
    v_fmac_f32_dpp v17, v111, v65 row_newbcast:12 row_mask:0xf bank_mask:0xf
    v_fmac_f32_dpp v12, v111, v66 row_newbcast:13 row_mask:0xf bank_mask:0xf
    v_fmac_f32_dpp v13, v111, v67 row_newbcast:13 row_mask:0xf bank_mask:0xf
    v_fmac_f32_dpp v16, v111, v68 row_newbcast:14 row_mask:0xf bank_mask:0xf
    v_fmac_f32_dpp v17, v111, v69 row_newbcast:14 row_mask:0xf bank_mask:0xf
    v_fmac_f32_dpp v12, v111, v70 row_newbcast:15 row_mask:0xf bank_mask:0xf
    v_fmac_f32_dpp v13, v111, v71 row_newbcast:15 row_mask:0xf bank_mask:0xf
    v_add_f32 v16, v16, v12
    v_add_f32 v17, v17, v13
    v_add_u32 v16, 0x800, v16
    v_add_u32 v17, 0x800, v17
    v_bfi_b32 v16, s100, v124, v16
    v_bfi_b32 v17, s100, v124, v17
    buffer_store_dwordx4 v[16:19], v109, s[16:19], s85 offen sc1
    v_mov_b32 v4, 28
    v_mov_b32 v5, 1
    s_mov_b64 exec, 1
    ds_add_u32 v4, v5
    s_mov_b64 exec, -1
    s_branch L_final
L_ogather:
    v_mov_b32 v4, 28
    s_mov_b32 s95, 0
L_cop_22:
    ds_read_b32 v5, v4
    s_waitcnt lgkmcnt(0)
    v_readfirstlane_b32 s89, v5
    s_nop 0
    s_cmp_ge_u32 s89, 2
    s_nop 1
    s_cbranch_scc1 L_copd_23
    s_add_u32 s95, s95, 1
    s_cmp_lt_u32 s95, 1000000
    s_cbranch_scc1 L_cop_22
L_copd_23:
    s_mov_b32 s91, 0x3fb8aa3b
    s_mov_b32 s95, 0
L_opl_24:
    buffer_load_dwordx4 v[40:43], v108, s[16:19], s85 offen sc1
    buffer_load_dwordx4 v[44:47], v108, s[16:19], s85 offen offset:16 sc1
    s_waitcnt vmcnt(0)
    v_xor_b32 v10, v124, v40
    v_xor_b32 v11, v124, v41
    v_or_b32 v10, v10, v11
    v_xor_b32 v11, v124, v42
    v_or_b32 v10, v10, v11
    v_xor_b32 v11, v124, v43
    v_or_b32 v10, v10, v11
    v_xor_b32 v11, v124, v44
    v_or_b32 v10, v10, v11
    v_xor_b32 v11, v124, v45
    v_or_b32 v10, v10, v11
    v_xor_b32 v11, v124, v46
    v_or_b32 v10, v10, v11
    v_xor_b32 v11, v124, v47
    v_or_b32 v10, v10, v11
    v_and_b32 v10, s100, v10
    v_cmp_ne_u32 vcc, 0, v10
    s_nop 3
    s_cbranch_vccz L_opk_25
    s_mov_b64 exec, vcc
    s_add_u32 s95, s95, 1
    s_cmp_lt_u32 s95, 1000000
    s_cbranch_scc1 L_opl_24
L_opk_25:
    s_mov_b64 exec, -1
    v_and_b32 v42, 0xfffff000, v42
    v_and_b32 v40, 0xfffff000, v40
    v_and_b32 v41, 0xfffff000, v41
    v_and_b32 v44, 0xfffff000, v44
    v_and_b32 v45, 0xfffff000, v45
    v_and_b32 v43, 0xfffff000, v43
    v_max_f32_dpp v12, v42, v42 quad_perm:[1,0,3,2] row_mask:0xf bank_mask:0xf
    s_nop 1
    v_max_f32_dpp v12, v12, v12 quad_perm:[2,3,0,1] row_mask:0xf bank_mask:0xf
    s_nop 1
    v_max_f32_dpp v12, v12, v12 row_ror:8 row_mask:0xf bank_mask:0xf
    v_sub_f32 v42, v42, v12
    v_mul_f32 v42, s91, v42
    v_exp_f32 v42, v42
    s_nop 0
    v_mul_f32 v43, v43, v42
    v_mul_f32 v40, v40, v42
    v_mul_f32 v41, v41, v42
    v_mul_f32 v44, v44, v42
    v_mul_f32 v45, v45, v42
    v_add_f32_dpp v43, v43, v43 quad_perm:[1,0,3,2] row_mask:0xf bank_mask:0xf
    v_add_f32_dpp v40, v40, v40 quad_perm:[1,0,3,2] row_mask:0xf bank_mask:0xf
    v_add_f32_dpp v41, v41, v41 quad_perm:[1,0,3,2] row_mask:0xf bank_mask:0xf
    v_add_f32_dpp v44, v44, v44 quad_perm:[1,0,3,2] row_mask:0xf bank_mask:0xf
    v_add_f32_dpp v45, v45, v45 quad_perm:[1,0,3,2] row_mask:0xf bank_mask:0xf
    v_add_f32_dpp v43, v43, v43 quad_perm:[2,3,0,1] row_mask:0xf bank_mask:0xf
    v_add_f32_dpp v40, v40, v40 quad_perm:[2,3,0,1] row_mask:0xf bank_mask:0xf
    v_add_f32_dpp v41, v41, v41 quad_perm:[2,3,0,1] row_mask:0xf bank_mask:0xf
    v_add_f32_dpp v44, v44, v44 quad_perm:[2,3,0,1] row_mask:0xf bank_mask:0xf
    v_add_f32_dpp v45, v45, v45 quad_perm:[2,3,0,1] row_mask:0xf bank_mask:0xf
    v_add_f32_dpp v43, v43, v43 row_ror:8 row_mask:0xf bank_mask:0xf
    v_add_f32_dpp v40, v40, v40 row_ror:8 row_mask:0xf bank_mask:0xf
    v_add_f32_dpp v41, v41, v41 row_ror:8 row_mask:0xf bank_mask:0xf
    v_add_f32_dpp v44, v44, v44 row_ror:8 row_mask:0xf bank_mask:0xf
    v_add_f32_dpp v45, v45, v45 row_ror:8 row_mask:0xf bank_mask:0xf
    v_rcp_f32 v42, v43
    s_nop 0
    v_mul_f32 v40, v40, v42
    v_mul_f32 v41, v41, v42
    v_mul_f32 v44, v44, v42
    v_mul_f32 v45, v45, v42
    v_cvt_pk_bf16_f32 v16, v40, v41
    v_cvt_pk_bf16_f32 v17, v44, v45
    ds_write_b64 v109, v[16:17] offset:6016
    s_branch L_final
L_stagec:
    ds_read_b128 v[12:15], v111 offset:3328
    v_mov_b32 v11, 0
    v_mov_b32 v79, 0
    v_mov_b32 v83, 0
    v_mov_b32 v87, 0
    v_mov_b32 v91, 0
    v_mov_b32 v95, 0
    v_mov_b32 v99, 0
    v_mov_b32 v103, 0
    v_mov_b32 v107, 0
    v_mov_b32 v4, 12
    s_mov_b32 s95, 0
L_cc_26:
    ds_read_b32 v5, v4
    s_waitcnt lgkmcnt(0)
    v_readfirstlane_b32 s89, v5
    s_nop 0
    s_cmp_ge_u32 s89, 3
    s_nop 1
    s_cbranch_scc1 L_ccd_27
    s_add_u32 s95, s95, 1
    s_cmp_lt_u32 s95, 1000000
    s_cbranch_scc1 L_cc_26
L_ccd_27:
    ds_read_b128 v[40:43], v108 offset:40960
    ds_read_b128 v[44:47], v108 offset:41984
    ds_read_b128 v[48:51], v108 offset:43008
    ds_read_b128 v[52:55], v108 offset:44032
    ds_read_b128 v[56:59], v108 offset:45056
    ds_read_b128 v[60:63], v108 offset:46080
    ds_read_b128 v[64:67], v108 offset:47104
    ds_read_b128 v[68:71], v108 offset:48128
    ds_read_b128 v[72:75], v108 offset:49152
    s_mov_b32 s96, -1
    s_mov_b32 s97, 0
    s_waitcnt lgkmcnt(0)
    v_cndmask_b32_e64 v72, 0, v72, s[96:97]
    v_cndmask_b32_e64 v73, 0, v73, s[96:97]
    v_cndmask_b32_e64 v74, 0, v74, s[96:97]
    v_cndmask_b32_e64 v75, 0, v75, s[96:97]
    v_perm_b32 v76, v60, v56, s80
    v_perm_b32 v77, v68, v64, s80
    v_perm_b32 v78, v11, v72, s80
    v_perm_b32 v20, v44, v40, s80
    v_perm_b32 v21, v52, v48, s80
    v_perm_b32 v80, v60, v56, s81
    v_perm_b32 v81, v68, v64, s81
    v_perm_b32 v82, v11, v72, s81
    v_perm_b32 v22, v44, v40, s81
    v_perm_b32 v23, v52, v48, s81
    v_perm_b32 v84, v61, v57, s80
    v_perm_b32 v85, v69, v65, s80
    v_perm_b32 v86, v11, v73, s80
    v_perm_b32 v24, v45, v41, s80
    v_perm_b32 v25, v53, v49, s80
    v_perm_b32 v88, v61, v57, s81
    v_perm_b32 v89, v69, v65, s81
    v_perm_b32 v90, v11, v73, s81
    v_perm_b32 v26, v45, v41, s81
    v_perm_b32 v27, v53, v49, s81
    v_perm_b32 v92, v62, v58, s80
    v_perm_b32 v93, v70, v66, s80
    v_perm_b32 v94, v11, v74, s80
    v_perm_b32 v28, v46, v42, s80
    v_perm_b32 v29, v54, v50, s80
    v_perm_b32 v96, v62, v58, s81
    v_perm_b32 v97, v70, v66, s81
    v_perm_b32 v98, v11, v74, s81
    v_perm_b32 v30, v46, v42, s81
    v_perm_b32 v31, v54, v50, s81
    v_perm_b32 v100, v63, v59, s80
    v_perm_b32 v101, v71, v67, s80
    v_perm_b32 v102, v11, v75, s80
    v_perm_b32 v32, v47, v43, s80
    v_perm_b32 v33, v55, v51, s80
    v_perm_b32 v104, v63, v59, s81
    v_perm_b32 v105, v71, v67, s81
    v_perm_b32 v106, v11, v75, s81
    v_perm_b32 v34, v47, v43, s81
    v_perm_b32 v35, v55, v51, s81
    v_cndmask_b32_e64 v118, 0, v12, s[64:65]
    v_cndmask_b32_e64 v119, 0, v13, s[64:65]
    v_cndmask_b32_e64 v120, 0, v14, s[64:65]
    v_cndmask_b32_e64 v121, 0, v15, s[64:65]
    s_nop 1
    v_mfma_f32_16x16x32_bf16 v[16:19], v[118:121], v[76:79], 0
    v_cndmask_b32_e64 v36, 0, v12, s[66:67]
    v_cndmask_b32_e64 v37, 0, v13, s[66:67]
    v_cndmask_b32_e64 v38, 0, v14, s[66:67]
    v_cndmask_b32_e64 v39, 0, v15, s[66:67]
    s_nop 1
    v_mfma_f32_16x16x32_bf16 v[16:19], v[36:39], v[80:83], v[16:19]
    v_cndmask_b32_e64 v118, 0, v12, s[68:69]
    v_cndmask_b32_e64 v119, 0, v13, s[68:69]
    v_cndmask_b32_e64 v120, 0, v14, s[68:69]
    v_cndmask_b32_e64 v121, 0, v15, s[68:69]
    s_nop 1
    v_mfma_f32_16x16x32_bf16 v[16:19], v[118:121], v[84:87], v[16:19]
    v_cndmask_b32_e64 v36, 0, v12, s[70:71]
    v_cndmask_b32_e64 v37, 0, v13, s[70:71]
    v_cndmask_b32_e64 v38, 0, v14, s[70:71]
    v_cndmask_b32_e64 v39, 0, v15, s[70:71]
    s_nop 1
    v_mfma_f32_16x16x32_bf16 v[16:19], v[36:39], v[88:91], v[16:19]
    v_cndmask_b32_e64 v118, 0, v12, s[72:73]
    v_cndmask_b32_e64 v119, 0, v13, s[72:73]
    v_cndmask_b32_e64 v120, 0, v14, s[72:73]
    v_cndmask_b32_e64 v121, 0, v15, s[72:73]
    s_nop 1
    v_mfma_f32_16x16x32_bf16 v[16:19], v[118:121], v[92:95], v[16:19]
    v_cndmask_b32_e64 v36, 0, v12, s[74:75]
    v_cndmask_b32_e64 v37, 0, v13, s[74:75]
    v_cndmask_b32_e64 v38, 0, v14, s[74:75]
    v_cndmask_b32_e64 v39, 0, v15, s[74:75]
    s_nop 1
    v_mfma_f32_16x16x32_bf16 v[16:19], v[36:39], v[96:99], v[16:19]
    v_cndmask_b32_e64 v118, 0, v12, s[76:77]
    v_cndmask_b32_e64 v119, 0, v13, s[76:77]
    v_cndmask_b32_e64 v120, 0, v14, s[76:77]
    v_cndmask_b32_e64 v121, 0, v15, s[76:77]
    s_nop 1
    v_mfma_f32_16x16x32_bf16 v[16:19], v[118:121], v[100:103], v[16:19]
    v_cndmask_b32_e64 v36, 0, v12, s[78:79]
    v_cndmask_b32_e64 v37, 0, v13, s[78:79]
    v_cndmask_b32_e64 v38, 0, v14, s[78:79]
    v_cndmask_b32_e64 v39, 0, v15, s[78:79]
    s_nop 1
    v_mfma_f32_16x16x32_bf16 v[16:19], v[36:39], v[104:107], v[16:19]
    s_mov_b32 s95, 0
L_oaspin:
    ds_read_b64 v[12:13], v112 offset:6016
    s_waitcnt lgkmcnt(0)
    v_cmp_eq_u32 vcc, -1, v12
    s_nop 3
    s_cbranch_vccz L_oaok
    s_add_u32 s95, s95, 1
    s_cmp_lt_u32 s95, 1000000
    s_cbranch_scc1 L_oaspin
L_oaok:
    v_cndmask_b32_e64 v40, 0, v12, s[64:65]
    v_cndmask_b32_e64 v41, 0, v13, s[64:65]
    v_cndmask_b32_e64 v42, 0, v12, s[66:67]
    v_cndmask_b32_e64 v43, 0, v13, s[66:67]
    v_cndmask_b32_e64 v44, 0, v12, s[68:69]
    v_cndmask_b32_e64 v45, 0, v13, s[68:69]
    v_cndmask_b32_e64 v46, 0, v12, s[70:71]
    v_cndmask_b32_e64 v47, 0, v13, s[70:71]
    v_cndmask_b32_e64 v48, 0, v12, s[72:73]
    v_cndmask_b32_e64 v49, 0, v13, s[72:73]
    v_cndmask_b32_e64 v50, 0, v12, s[74:75]
    v_cndmask_b32_e64 v51, 0, v13, s[74:75]
    v_cndmask_b32_e64 v52, 0, v12, s[76:77]
    v_cndmask_b32_e64 v53, 0, v13, s[76:77]
    v_cndmask_b32_e64 v54, 0, v12, s[78:79]
    v_cndmask_b32_e64 v55, 0, v13, s[78:79]
    v_mfma_f32_16x16x16_bf16 v[16:19], v[40:41], v[20:21], v[16:19]
    v_mfma_f32_16x16x16_bf16 v[16:19], v[42:43], v[22:23], v[16:19]
    v_mfma_f32_16x16x16_bf16 v[16:19], v[44:45], v[24:25], v[16:19]
    v_mfma_f32_16x16x16_bf16 v[16:19], v[46:47], v[26:27], v[16:19]
    v_mfma_f32_16x16x16_bf16 v[16:19], v[48:49], v[28:29], v[16:19]
    v_mfma_f32_16x16x16_bf16 v[16:19], v[50:51], v[30:31], v[16:19]
    v_mfma_f32_16x16x16_bf16 v[16:19], v[52:53], v[32:33], v[16:19]
    v_mfma_f32_16x16x16_bf16 v[16:19], v[54:55], v[34:35], v[16:19]
    s_cmp_lg_u32 s36, 4
    s_nop 5
    s_cbranch_scc1 L_pfull_28
    s_mov_b32 exec_lo, 0x00ff00ff
    s_mov_b32 exec_hi, 0x00ff00ff
L_pfull_28:
    v_add_u32 v16, 0x800, v16
    v_add_u32 v17, 0x800, v17
    v_add_u32 v18, 0x800, v18
    v_add_u32 v19, 0x800, v19
    v_bfi_b32 v16, s100, v124, v16
    v_bfi_b32 v17, s100, v124, v17
    v_bfi_b32 v18, s100, v124, v18
    v_bfi_b32 v19, s100, v124, v19
    buffer_store_dwordx4 v[16:19], v110, s[16:19], s85 offen sc1
    s_mov_b64 exec, -1
    v_mov_b32 v4, 24
    v_mov_b32 v5, 1
    s_mov_b64 exec, 1
    ds_add_u32 v4, v5
    s_mov_b64 exec, -1
L_final:
    s_cmp_lt_u32 s101, 13
    s_cbranch_scc1 L_fin
    s_cmp_ge_u32 s37, 12
    s_cbranch_scc1 L_fin
    s_sub_u32 s89, s101, 13
    s_mul_i32 s101, s37, 3
    s_add_u32 s101, s101, s89
    v_bfe_u32 v104, v1, 4, 1
    v_mul_u32_u24 v104, 576, v104
    v_add_u32 v104, v104, v3
    s_lshl_b32 s89, s101, 4
    v_add_u32 v104, s89, v104
    v_lshlrev_b32 v104, 1, v104
    buffer_load_ushort v106, v104, s[28:31], 0 offen
    v_lshrrev_b32 v6, 3, v0
    v_mul_u32_u24 v6, 4608, v6
    v_and_b32 v7, 7, v0
    v_lshlrev_b32 v7, 4, v7
    v_add_u32 v6, v6, v7
    v_lshlrev_b32 v8, 2, v2
    v_add_u32 v8, v8, v7
    s_lshl_b32 s91, s36, 7
    v_add_u32 v8, s91, v8
    v_mov_b32 v4, 24
    s_mov_b32 s95, 0
L_cp_29:
    ds_read_b32 v5, v4
    s_waitcnt lgkmcnt(0)
    v_readfirstlane_b32 s89, v5
    s_nop 0
    s_cmp_ge_u32 s89, 5
    s_nop 1
    s_cbranch_scc1 L_cpd_30
    s_sleep 1
    s_add_u32 s95, s95, 1
    s_cmp_lt_u32 s95, 1000000
    s_cbranch_scc1 L_cp_29
L_cpd_30:
    s_lshl_b32 s89, s101, 7
    s_add_u32 s89, s89, 753664
    s_add_u32 s90, s89, 589824
    s_mov_b32 s95, 0
L_fpl_31:
    buffer_load_dwordx4 v[72:75], v6, s[16:19], s89 offen sc1
    buffer_load_dwordx4 v[76:79], v6, s[16:19], s90 offen sc1
    s_waitcnt vmcnt(0)
    v_xor_b32 v10, v124, v72
    v_xor_b32 v11, v124, v73
    v_or_b32 v10, v10, v11
    v_xor_b32 v11, v124, v74
    v_or_b32 v10, v10, v11
    v_xor_b32 v11, v124, v75
    v_or_b32 v10, v10, v11
    v_xor_b32 v11, v124, v76
    v_or_b32 v10, v10, v11
    v_xor_b32 v11, v124, v77
    v_or_b32 v10, v10, v11
    v_xor_b32 v11, v124, v78
    v_or_b32 v10, v10, v11
    v_xor_b32 v11, v124, v79
    v_or_b32 v10, v10, v11
    v_and_b32 v10, s100, v10
    v_cmp_ne_u32 vcc, 0, v10
    s_nop 3
    s_cbranch_vccz L_fpk_32
    s_mov_b64 exec, vcc
    s_add_u32 s95, s95, 1
    s_cmp_lt_u32 s95, 1000000
    s_cbranch_scc1 L_fpl_31
L_fpk_32:
    s_mov_b64 exec, -1
    v_and_b32 v72, 0xfffff000, v72
    v_and_b32 v73, 0xfffff000, v73
    v_and_b32 v74, 0xfffff000, v74
    v_and_b32 v75, 0xfffff000, v75
    v_and_b32 v76, 0xfffff000, v76
    v_and_b32 v77, 0xfffff000, v77
    v_and_b32 v78, 0xfffff000, v78
    v_and_b32 v79, 0xfffff000, v79
    v_add_f32 v72, v72, v76
    v_add_f32 v73, v73, v77
    v_add_f32 v74, v74, v78
    v_add_f32 v75, v75, v79
    v_add_f32_dpp v72, v72, v72 row_ror:8 row_mask:0xf bank_mask:0xf
    v_add_f32_dpp v73, v73, v73 row_ror:8 row_mask:0xf bank_mask:0xf
    v_add_f32_dpp v74, v74, v74 row_ror:8 row_mask:0xf bank_mask:0xf
    v_add_f32_dpp v75, v75, v75 row_ror:8 row_mask:0xf bank_mask:0xf
    v_permlane16_swap_b32 v72, v73
    s_nop 0
    v_permlane16_swap_b32 v74, v75
    v_add_f32 v72, v72, v73
    v_add_f32 v74, v74, v75
    s_nop 1
    v_permlane32_swap_b32 v72, v74
    v_add_f32 v12, v72, v74
    v_lshlrev_b32 v9, 2, v2
    v_add_u32 v9, v9, v7
    s_mov_b32 exec_lo, 0x00ff00ff
    s_mov_b32 exec_hi, 0x00ff00ff
    ds_add_f32 v9, v12 offset:3968
    v_mov_b32 v4, 36
    v_mov_b32 v5, 1
    s_mov_b64 exec, 1
    ds_add_rtn_u32 v5, v4, v5
    s_mov_b64 exec, -1
    v_and_b32 v7, 31, v1
    v_lshlrev_b32 v7, 2, v7
    s_waitcnt lgkmcnt(0)
    v_readfirstlane_b32 s89, v5
    s_nop 0
    s_cmp_lg_u32 s89, 15
    s_nop 1
    s_cbranch_scc1 L_fin
    ds_read_b32 v40, v7 offset:3968
    v_lshlrev_b32 v106, 16, v106
    s_waitcnt lgkmcnt(0)
    v_add_f32 v40, v40, v106
    v_cvt_pk_bf16_f32 v40, v40, v40
    s_mov_b32 exec_lo, -1
    s_mov_b32 exec_hi, 0
    buffer_store_short v40, v104, s[32:35], 0 offen
    s_cmp_lg_u32 s101, 0
    s_cbranch_scc1 L_fin0
    s_add_u32 s89, s83, 1
    v_mov_b32 v6, s89
    v_mov_b32 v7, 0
    s_mov_b64 exec, 1
    buffer_store_dword v6, v7, s[16:19], 0 offen
L_fin0:
L_fin:
L_end:
    s_endpgm
.section .rodata,"a"
.p2align 6
.amdhsa_kernel parallel_sum__gqa_block_cached__glu_gated_bilinear__decode_kernel
  .amdhsa_next_free_vgpr 128
  .amdhsa_next_free_sgpr 102
  .amdhsa_accum_offset 128
  .amdhsa_group_segment_fixed_size 0
  .amdhsa_kernarg_size 96
  .amdhsa_user_sgpr_count 2
  .amdhsa_user_sgpr_kernarg_segment_ptr 1
  .amdhsa_system_sgpr_workgroup_id_x 1
  .amdhsa_float_denorm_mode_32 3
.end_amdhsa_kernel
```
